```python
import torch

def _softmax(x, axis=-1):
    return torch.softmax(x, dim=axis)

def _gelu(x):
    return torch.nn.functional.gelu(x, approximate='tanh')

def _silu(x):
    return torch.nn.functional.silu(x)

def _sigmoid(x):
    return torch.sigmoid(x)

def _layernorm(x, axis=-1, eps=1e-05):
    m = x.mean(dim=axis, keepdim=True)
    v = x.var(dim=axis, keepdim=True, unbiased=False)
    return (x - m) / torch.sqrt(v + eps)

def _scatter_add(tgt, idx, src, axis=0):
    return tgt.clone().index_add_(axis, idx, src)

def _segment_sum(src, seg, n):
    out = torch.zeros((n,) + src.shape[1:], dtype=src.dtype)
    return out.index_add_(0, seg, src)

def _pad(x, pw):
    flat = tuple((v for pair in reversed(pw) for v in pair))
    return torch.nn.functional.pad(x, flat)
kernel_name = 'standalone__video_video_swin__vision'

def setup_inputs():

    _w = lambda a: (lambda t: t.to(torch.bfloat16) if t.is_floating_point() else t)(torch.as_tensor(a))
    T = 4
    H = W = 512 // 7 * 7
    C, win = (96, 7)
    return {'x': _w((lambda *s: torch.randn(*s, dtype=torch.bfloat16) * 0.1)(1, T, H, W, C)), 'wqkv_t': _w((lambda *s: torch.randn(*s, dtype=torch.bfloat16) * 0.1)(C, 3 * C)), 'wo_t': _w((lambda *s: torch.randn(*s, dtype=torch.bfloat16) * 0.1)(C, C)), 'wqkv_s': _w((lambda *s: torch.randn(*s, dtype=torch.bfloat16) * 0.1)(C, 3 * C)), 'wo_s': _w((lambda *s: torch.randn(*s, dtype=torch.bfloat16) * 0.05)(C, C))}

def reference(x, wqkv_t, wo_t, wqkv_s, wo_s):
    B, T, H, W, C = x.shape
    win = 7
    scale = C ** (-0.5)
    h = _layernorm(x, axis=-1)
    ht = (lambda x, *d: x.permute(*d))(h, 0, 2, 3, 1, 4).reshape(B * H * W, T, C)
    qkv = ht @ wqkv_t
    q, k, v = (qkv[..., :C].clone(), qkv[..., C:2 * C].clone(), qkv[..., 2 * C:].clone())
    p = _softmax(torch.einsum('btc,bsc->bts', q, k) * scale, axis=-1)
    ot = torch.einsum('bts,bsc->btc', p, v) @ wo_t
    ot = (lambda x, *d: x.permute(*d))(ot.reshape(B, H, W, T, C), 0, 3, 1, 2, 4)
    x = x + ot
    h = _layernorm(x, axis=-1)
    nh, nw = (H // win, W // win)
    hs = h.reshape(B * T, nh, win, nw, win, C)
    hw = (lambda x, *d: x.permute(*d))(hs, 0, 1, 3, 2, 4, 5).reshape(B * T * nh * nw, win * win, C)
    qkv = hw @ wqkv_s
    q, k, v = (qkv[..., :C].clone(), qkv[..., C:2 * C].clone(), qkv[..., 2 * C:].clone())
    p = _softmax(torch.einsum('bqc,bkc->bqk', q, k) * scale, axis=-1)
    os = torch.einsum('bqk,bkc->bqc', p, v) @ wo_s
    os = (lambda x, *d: x.permute(*d))(os.reshape(B * T, nh, nw, win, win, C), 0, 1, 3, 2, 4, 5)
    os = os.reshape(B, T, H, W, C)
    return x + os
```

```asm
; @launch grid=(256,1,1) block=(512,1,1) lds=163840
.amdgcn_target "amdgcn-amd-amdhsa--gfx950"
.text
.globl standalone__video_video_swin__vision_kernel
.p2align 8
.type standalone__video_video_swin__vision_kernel,@function
standalone__video_video_swin__vision_kernel:
  s_cmp_ge_u32 s2, 256
  s_cbranch_scc1 main_end
  s_load_dwordx2 s[4:5], s[0:1], 0

  s_load_dwordx8 s[60:67], s[0:1], 8
  s_load_dwordx2 s[8:9], s[0:1], 40
  s_load_dwordx2 s[12:13], s[0:1], 56
  s_mov_b32 s6, 200540928
  s_mov_b32 s7, 0x20000
  s_mov_b32 s10, 200540928
  s_mov_b32 s11, 0x20000
  s_mov_b32 s14, 92160
  s_mov_b32 s15, 0x20000
  s_mul_i32 s16, s2, 5329
  s_add_u32 s17, s16, 5329
  s_lshr_b32 s16, s16, 8
  s_lshr_b32 s17, s17, 8
  s_sub_u32 s51, s17, 1
  s_sub_u32 s17, s17, s16
  v_lshrrev_b32 v24, 6, v0
  v_and_b32 v25, 63, v0
  s_mov_b32 s30, 0x00f0000f
  s_mov_b32 s31, 0xf0000f00
  v_readfirstlane_b32 s18, v24
  s_mov_b32 s32, 0xaaaaaaaa
  s_mov_b32 s33, 0xaaaaaaaa
  s_mov_b32 s34, 0xcccccccc
  s_mov_b32 s35, 0xcccccccc
  s_mov_b32 s38, 0xffff0000
  s_mov_b32 s39, 0xffff0000
  s_mov_b32 s40, 0xffff
  s_mov_b32 s41, 0
  s_mov_b32 s42, 0xffff0000
  s_mov_b32 s43, 0xbc2aaaab
  s_mov_b32 s48, 58835169
  s_mov_b32 s49, 96768
  s_mov_b32 s50, 50135232
  s_lshr_b32 s19, s18, 2
  s_and_b32 s20, s18, 3
  s_mov_b32 s21, s19
  s_mul_i32 s45, s18, 9456
  s_add_u32 s45, s45, 73728
  v_lshlrev_b32 v1, 4, v25
  v_bfe_u32 v26, v25, 2, 2
  v_and_b32 v27, 3, v25
  v_lshrrev_b32 v28, 4, v25
  v_lshlrev_b32 v28, 4, v28
  s_lshl_b32 s24, s18, 2
  s_add_u32 s24, s24, s16
  v_add_u32 v29, s24, v26
  v_min_u32 v29, s51, v29
  v_mul_hi_u32 v30, v29, s48
  v_mul_u32_u24 v31, 73, v30
  v_sub_u32 v31, v29, v31
  s_mov_b32 s24, 686784
  v_mul_lo_u32 v30, v30, s24
  v_mul_u32_u24 v31, 1344, v31
  v_mul_lo_u32 v32, v27, s50
  v_add3_u32 v90, v30, v31, v32
  v_add_u32 v90, v90, v28
  s_mul_i32 s52, s18, 1536
  s_add_u32 s52, s52, 149376
  s_mov_b32 s53, 589824
  s_mul_i32 s24, s2, 98304
  s_add_u32 s24, s24, 0x200000
  s_mov_b32 s90, 98304
  s_mov_b32 s91, 0x20000
  s_waitcnt lgkmcnt(0)
  s_add_u32 s88, s12, s24
  s_addc_u32 s89, s13, 0
  s_lshl_b32 s24, s18, 5
  s_and_b32 s24, s24, 32
  s_cmp_ge_u32 s18, 6
  s_cselect_b32 s24, 0, s24
  v_lshrrev_b32 v29, 5, v25
  v_xor_b32 v96, s24, v1
  v_lshlrev_b32 v29, 4, v29
  v_xor_b32 v98, 16, v96
  v_xor_b32 v97, v29, v96
  s_mov_b32 s83, 0x20000
  s_mov_b32 s87, 0x20000
  s_cbranch_scc1 main_noE0
  s_mov_b32 s80, s60
  s_mov_b32 s81, s61
  s_mov_b32 s82, 55296
  s_mov_b32 s84, s64
  s_mov_b32 s85, s65
  s_mov_b32 s86, 55296
  s_mul_i32 s24, s18, 9216
  s_mov_b32 m0, s24
  s_nop 0
  buffer_load_dwordx4 v96, s[80:83], s24 offen lds
  s_add_u32 m0, s24, 55296
  s_nop 0
  buffer_load_dwordx4 v96, s[84:87], s24 offen lds
  s_add_u32 s24, s24, 1024
  s_mov_b32 m0, s24
  s_nop 0
  buffer_load_dwordx4 v96, s[80:83], s24 offen lds
  s_add_u32 m0, s24, 55296
  s_nop 0
  buffer_load_dwordx4 v96, s[84:87], s24 offen lds
  s_add_u32 s24, s24, 1024
  s_mov_b32 m0, s24
  s_nop 0
  buffer_load_dwordx4 v96, s[80:83], s24 offen lds
  s_add_u32 m0, s24, 55296
  s_nop 0
  buffer_load_dwordx4 v96, s[84:87], s24 offen lds
  s_add_u32 s24, s24, 1024
  s_mov_b32 m0, s24
  s_nop 0
  buffer_load_dwordx4 v96, s[80:83], s24 offen lds
  s_add_u32 m0, s24, 55296
  s_nop 0
  buffer_load_dwordx4 v96, s[84:87], s24 offen lds
  s_add_u32 s24, s24, 1024
  s_mov_b32 m0, s24
  s_nop 0
  buffer_load_dwordx4 v97, s[80:83], s24 offen lds
  s_add_u32 m0, s24, 55296
  s_nop 0
  buffer_load_dwordx4 v97, s[84:87], s24 offen lds
  s_add_u32 s24, s24, 1024
  s_mov_b32 m0, s24
  s_nop 0
  buffer_load_dwordx4 v98, s[80:83], s24 offen lds
  s_add_u32 m0, s24, 55296
  s_nop 0
  buffer_load_dwordx4 v98, s[84:87], s24 offen lds
  s_add_u32 s24, s24, 1024
  s_mov_b32 m0, s24
  s_nop 0
  buffer_load_dwordx4 v98, s[80:83], s24 offen lds
  s_add_u32 m0, s24, 55296
  s_nop 0
  buffer_load_dwordx4 v98, s[84:87], s24 offen lds
  s_add_u32 s24, s24, 1024
  s_mov_b32 m0, s24
  s_nop 0
  buffer_load_dwordx4 v98, s[80:83], s24 offen lds
  s_add_u32 m0, s24, 55296
  s_nop 0
  buffer_load_dwordx4 v98, s[84:87], s24 offen lds
  s_add_u32 s24, s24, 1024
  s_mov_b32 m0, s24
  s_nop 0
  buffer_load_dwordx4 v98, s[80:83], s24 offen lds
  s_add_u32 m0, s24, 55296
  s_nop 0
  buffer_load_dwordx4 v98, s[84:87], s24 offen lds
  s_add_u32 s24, s24, 1024
  buffer_load_dwordx4 v[72:75], v90, s[4:7], s53 offen offset:0 nt
  buffer_load_dwordx4 v[76:79], v90, s[4:7], s53 offen offset:64 nt
  buffer_load_dwordx4 v[80:83], v90, s[4:7], s53 offen offset:128 nt
  s_branch main_ld0
main_noE0:
  v_xor_b32 v99, 32, v96
  v_xor_b32 v100, 32, v97
  v_xor_b32 v101, 32, v98
  s_cmp_eq_u32 s18, 6
  s_cselect_b32 s80, s62, s66
  s_cselect_b32 s81, s63, s67
  s_mov_b32 s82, 18432
  s_mul_i32 s25, s18, 18432
  s_mov_b32 s24, 0
  s_add_u32 m0, s25, s24
  s_nop 0
  buffer_load_dwordx4 v96, s[80:83], s24 offen lds
  s_add_u32 s24, s24, 1024
  s_add_u32 m0, s25, s24
  s_nop 0
  buffer_load_dwordx4 v97, s[80:83], s24 offen lds
  s_add_u32 s24, s24, 1024
  s_add_u32 m0, s25, s24
  s_nop 0
  buffer_load_dwordx4 v98, s[80:83], s24 offen lds
  s_add_u32 s24, s24, 1024
  s_add_u32 m0, s25, s24
  s_nop 0
  buffer_load_dwordx4 v99, s[80:83], s24 offen lds
  s_add_u32 s24, s24, 1024
  s_add_u32 m0, s25, s24
  s_nop 0
  buffer_load_dwordx4 v100, s[80:83], s24 offen lds
  s_add_u32 s24, s24, 1024
  s_add_u32 m0, s25, s24
  s_nop 0
  buffer_load_dwordx4 v101, s[80:83], s24 offen lds
  s_add_u32 s24, s24, 1024
  s_add_u32 m0, s25, s24
  s_nop 0
  buffer_load_dwordx4 v96, s[80:83], s24 offen lds
  s_add_u32 s24, s24, 1024
  s_add_u32 m0, s25, s24
  s_nop 0
  buffer_load_dwordx4 v97, s[80:83], s24 offen lds
  s_add_u32 s24, s24, 1024
  s_add_u32 m0, s25, s24
  s_nop 0
  buffer_load_dwordx4 v98, s[80:83], s24 offen lds
  s_add_u32 s24, s24, 1024
  s_add_u32 m0, s25, s24
  s_nop 0
  buffer_load_dwordx4 v99, s[80:83], s24 offen lds
  s_add_u32 s24, s24, 1024
  s_add_u32 m0, s25, s24
  s_nop 0
  buffer_load_dwordx4 v100, s[80:83], s24 offen lds
  s_add_u32 s24, s24, 1024
  s_add_u32 m0, s25, s24
  s_nop 0
  buffer_load_dwordx4 v101, s[80:83], s24 offen lds
  s_add_u32 s24, s24, 1024
  s_add_u32 m0, s25, s24
  s_nop 0
  buffer_load_dwordx4 v96, s[80:83], s24 offen lds
  s_add_u32 s24, s24, 1024
  s_add_u32 m0, s25, s24
  s_nop 0
  buffer_load_dwordx4 v97, s[80:83], s24 offen lds
  s_add_u32 s24, s24, 1024
  s_add_u32 m0, s25, s24
  s_nop 0
  buffer_load_dwordx4 v98, s[80:83], s24 offen lds
  s_add_u32 s24, s24, 1024
  s_add_u32 m0, s25, s24
  s_nop 0
  buffer_load_dwordx4 v99, s[80:83], s24 offen lds
  s_add_u32 s24, s24, 1024
  s_add_u32 m0, s25, s24
  s_nop 0
  buffer_load_dwordx4 v100, s[80:83], s24 offen lds
  s_add_u32 s24, s24, 1024
  s_add_u32 m0, s25, s24
  s_nop 0
  buffer_load_dwordx4 v101, s[80:83], s24 offen lds
  s_add_u32 s24, s24, 1024
main_ld0:
  v_lshl_add_u32 v29, v26, 3, v27
  v_lshlrev_b32 v30, 4, v26
  v_xor_b32 v30, v30, v28
  v_mul_u32_u24 v84, 576, v29
  v_mul_u32_u24 v85, 192, v29
  s_cmp_ge_u32 s18, 3
  s_cbranch_scc1 main_ldV
  v_mov_b32 v85, v84
  s_cmp_eq_u32 s18, 0
  s_cselect_b32 s60, 0, 55296
  s_mul_i32 s24, s18, 36864
  s_add_u32 s25, s24, 14336
  s_cmp_eq_u32 s18, 2
  s_cselect_b32 s24, 149376, s24
  s_cselect_b32 s25, 130464, s25
  s_cselect_b32 s62, 192, 0
  s_cselect_b32 s61, 0, 192
  s_add_u32 s61, s61, s60
  s_add_u32 s60, s62, s60
  s_mov_b32 s26, 0xbe16c740
  s_mov_b32 s28, 0x41622adf
  s_branch main_ld1
main_ldV:
  s_cmp_ge_u32 s18, 5
  s_cselect_b32 s63, 1, 0
  s_mul_i32 s60, s63, 55296
  s_add_u32 s60, s60, 384
  s_mul_i32 s61, s63, 18432
  s_add_u32 s61, s61, 110592
  s_mul_i32 s24, s63, 36864
  s_add_u32 s24, s24, 18432
  s_add_u32 s25, s24, 14336
  s_mov_b32 s26, 0xbdd105ec
  s_mov_b32 s28, 0x411cc471
main_ld1:
  s_mov_b32 s29, s28
  v_add3_u32 v84, v84, v30, s60
  v_add3_u32 v85, v85, v30, s61
  v_add_u32 v88, s24, v1
  v_add_u32 v89, s25, v1
  s_mul_i32 s24, s20, 3
  s_add_u32 s24, s24, 0
  s_lshl_b32 s24, s24, 2
  v_mul_u32_u24 v32, 43, v25
  v_lshrrev_b32 v32, 9, v32
  v_add_u32 v29, s24, v32
  v_mul_u32_u24 v32, 192, v32
  v_sub_u32 v32, v1, v32
  v_mul_u32_u24 v31, 37, v29
  v_lshrrev_b32 v31, 8, v31
  v_mul_u32_u24 v3, 192, v29
  v_mul_u32_u24 v31, s49, v31
  v_add_u32 v3, v3, v31
  v_add_u32 v3, v3, v32
  s_mul_i32 s24, s20, 3
  s_add_u32 s24, s24, 1
  s_lshl_b32 s24, s24, 2
  v_mul_u32_u24 v32, 43, v25
  v_lshrrev_b32 v32, 9, v32
  v_add_u32 v29, s24, v32
  v_mul_u32_u24 v32, 192, v32
  v_sub_u32 v32, v1, v32
  v_mul_u32_u24 v31, 37, v29
  v_lshrrev_b32 v31, 8, v31
  v_mul_u32_u24 v4, 192, v29
  v_mul_u32_u24 v31, s49, v31
  v_add_u32 v4, v4, v31
  v_add_u32 v4, v4, v32
  s_mul_i32 s24, s20, 3
  s_add_u32 s24, s24, 2
  s_lshl_b32 s24, s24, 2
  v_mul_u32_u24 v32, 43, v25
  v_lshrrev_b32 v32, 9, v32
  v_add_u32 v29, s24, v32
  v_mul_u32_u24 v32, 192, v32
  v_sub_u32 v32, v1, v32
  v_mul_u32_u24 v31, 37, v29
  v_lshrrev_b32 v31, 8, v31
  v_mul_u32_u24 v5, 192, v29
  v_mul_u32_u24 v31, s49, v31
  v_add_u32 v5, v5, v31
  v_add_u32 v5, v5, v32
  s_add_u32 s27, s16, s21
  s_mul_hi_u32 s24, s27, s48
  s_mul_i32 s25, s24, 73
  s_sub_u32 s25, s27, s25
  s_mul_i32 s24, s24, 686784
  s_mul_i32 s25, s25, 1344
  s_add_u32 s22, s24, s25
  s_mov_b32 s54, 0xff0ffff0
  s_mov_b32 s55, 0xffff0ff
  s_mov_b32 s56, 0xf0ffff0f
  s_mov_b32 s57, 0xfff00fff
  s_mov_b32 s58, 0xffff0ff
  s_mov_b32 s59, 0xff0ffff0
  v_lshrrev_b32 v29, 4, v25
  v_and_b32 v34, 15, v25
  v_sub_u32 v30, v26, v29
  v_and_b32 v30, 3, v30
  v_lshl_add_u32 v31, v30, 2, v29
  v_lshl_add_u32 v31, v31, 2, v27
  s_add_u32 s24, s52, 1024
  v_lshl_add_u32 v7, v31, 2, s24
  v_mov_b32 v32, 0x40000
  v_cmp_eq_u32 vcc, 3, v30
  v_add_u32 v8, 36864, v1
  v_mov_b32 v9, 0xff800000
  v_cndmask_b32 v7, v7, v32, vcc
  v_cndmask_b32 v9, v9, 0, s[40:41]
  v_add_u32 v12, s52, v28
  v_lshl_add_u32 v14, v34, 2, s52
  v_lshl_add_u32 v16, v34, 1, s52
  v_cndmask_b32 v16, v32, v16, s[40:41]
  v_mov_b32 v18, 0
  v_mov_b32 v19, 0
  v_mov_b32 v22, 0
  v_mov_b32 v23, 0
  v_mov_b32 v33, 0x3f80
  v_mov_b32 v31, 0x3f800000
  v_cndmask_b32 v33, v33, v31, s[32:33]
  v_cndmask_b32 v33, 0, v33, s[30:31]
  v_cndmask_b32 v20, v33, 0, s[34:35]
  v_cndmask_b32 v21, 0, v33, s[34:35]
  v_cmp_eq_u32 vcc, 0, v27
  v_add_u32 v33, 192, v12
  v_add_u32 v31, 161664, v28
  v_cndmask_b32 v11, v32, v12, vcc
  v_cmp_eq_u32 vcc, 1, v34
  s_nop 1
  v_cndmask_b32 v11, v11, v33, vcc
  v_cmp_eq_u32 vcc, 2, v27
  v_lshrrev_b32 v33, 5, v25
  v_bfe_u32 v35, v25, 4, 1
  v_cndmask_b32 v11, v11, v31, vcc
  v_lshl_add_u32 v33, v33, 2, v26
  v_lshl_add_u32 v33, v33, 1, v35
  v_lshl_add_u32 v33, v33, 2, v27
  s_add_u32 s24, s52, 1280
  v_lshl_add_u32 v17, v33, 1, s24
  s_mov_b32 s80, s4
  s_mov_b32 s81, s5
  s_mov_b32 s83, 0x20000
  s_mov_b32 s36, 0
  s_mov_b32 s37, 0xfffe0000
  v_mul_u32_u24 v31, 192, v26
  v_mul_u32_u24 v32, 784, v27
  v_add3_u32 v31, v31, v32, v28
  v_add_u32 v6, s45, v31
  v_mul_u32_u24 v31, 3152, v26
  v_mul_u32_u24 v32, 192, v27
  v_add3_u32 v31, v31, v32, v28
  s_mul_i32 s24, s19, 37824
  s_mul_i32 s25, s20, 784
  s_add_u32 s24, s24, 73728
  s_add_u32 s24, s24, s25
  v_add_u32 v10, s24, v31
  s_lshl_b32 s24, s18, 14
  v_lshl_add_u32 v93, v34, 10, s24
  v_add_u32 v91, v93, v28
  v_lshl_add_u32 v92, v29, 3, v93
  v_bfrev_b32 v35, 1
  v_cndmask_b32 v93, v35, v93, s[30:31]
  s_mul_i32 s24, s20, s50
  v_add_u32 v33, s24, v28
  v_mul_u32_u24 v31, 37, v34
  v_lshrrev_b32 v31, 8, v31
  v_mul_u32_u24 v15, 192, v34
  v_mul_u32_u24 v31, s49, v31
  v_add_u32 v15, v15, v31
  v_add_u32 v15, v15, v33
  v_add_u32 v34, 16, v34
  v_mul_u32_u24 v31, 37, v34
  v_lshrrev_b32 v31, 8, v31
  v_mul_u32_u24 v0, 192, v34
  v_mul_u32_u24 v31, s49, v31
  v_add_u32 v0, v0, v31
  v_add_u32 v0, v0, v33
  v_add_u32 v34, 16, v34
  v_mul_u32_u24 v31, 37, v34
  v_lshrrev_b32 v31, 8, v31
  v_mul_u32_u24 v2, 192, v34
  v_mul_u32_u24 v31, s49, v31
  v_add_u32 v2, v2, v31
  v_add_u32 v2, v2, v33
  v_add_u32 v34, 16, v34
  v_mul_u32_u24 v31, 37, v34
  v_lshrrev_b32 v31, 8, v31
  v_mul_u32_u24 v13, 192, v34
  v_mul_u32_u24 v31, s49, v31
  v_add_u32 v13, v13, v31
  v_add_u32 v13, v13, v33
  v_add_u32 v34, 16, v34
  v_cmp_lt_u32 vcc, 64, v34
  s_nop 1
  v_cndmask_b32 v13, v13, v35, vcc
  v_add_u32 v94, 149376, v1

  s_cmp_lt_u32 s18, 6
  s_cbranch_scc1 main_r0
  s_waitcnt vmcnt(0)
main_r0:
  s_waitcnt vmcnt(3)
  s_barrier
  s_cmp_eq_u32 s18, 6
  s_cbranch_scc1 main_r1
  s_cmp_ge_u32 s18, 3
  s_cbranch_scc1 main_rV
  ds_read_b128 v[96:99], v84 offset:0
  ds_read_b128 v[168:171], v85 offset:0
  ds_read_b128 v[108:111], v84 offset:2304
  ds_read_b128 v[180:183], v85 offset:2304
  ds_read_b128 v[120:123], v84 offset:18432
  ds_read_b128 v[192:195], v85 offset:18432
  ds_read_b128 v[132:135], v84 offset:20736
  ds_read_b128 v[204:207], v85 offset:20736
  ds_read_b128 v[144:147], v84 offset:36864
  ds_read_b128 v[216:219], v85 offset:36864
  ds_read_b128 v[156:159], v84 offset:39168
  ds_read_b128 v[228:231], v85 offset:39168
  s_waitcnt lgkmcnt(13)
  ds_read_b128 v[100:103], v84 offset:64
  ds_read_b128 v[172:175], v85 offset:64
  s_waitcnt lgkmcnt(13)
  ds_read_b128 v[112:115], v84 offset:2368
  ds_read_b128 v[184:187], v85 offset:2368
  s_waitcnt lgkmcnt(13)
  ds_read_b128 v[124:127], v84 offset:18496
  ds_read_b128 v[196:199], v85 offset:18496
  s_waitcnt lgkmcnt(13)
  ds_read_b128 v[136:139], v84 offset:20800
  ds_read_b128 v[208:211], v85 offset:20800
  s_waitcnt lgkmcnt(13)
  ds_read_b128 v[148:151], v84 offset:36928
  ds_read_b128 v[220:223], v85 offset:36928
  s_waitcnt lgkmcnt(13)
  ds_read_b128 v[160:163], v84 offset:39232
  ds_read_b128 v[232:235], v85 offset:39232
  s_waitcnt lgkmcnt(13)
  ds_read_b128 v[104:107], v84 offset:128
  ds_read_b128 v[176:179], v85 offset:128
  s_waitcnt lgkmcnt(13)
  ds_read_b128 v[116:119], v84 offset:2432
  ds_read_b128 v[188:191], v85 offset:2432
  s_waitcnt lgkmcnt(13)
  ds_read_b128 v[128:131], v84 offset:18560
  ds_read_b128 v[200:203], v85 offset:18560
  s_waitcnt lgkmcnt(13)
  ds_read_b128 v[140:143], v84 offset:20864
  ds_read_b128 v[212:215], v85 offset:20864
  s_waitcnt lgkmcnt(13)
  ds_read_b128 v[152:155], v84 offset:36992
  ds_read_b128 v[224:227], v85 offset:36992
  s_waitcnt lgkmcnt(13)
  ds_read_b128 v[164:167], v84 offset:39296
  ds_read_b128 v[236:239], v85 offset:39296
  s_branch main_r1
main_rV:
  ds_read_b128 v[96:99], v84 offset:0
  ds_read_b128 v[168:171], v85 offset:0
  ds_read_b128 v[108:111], v84 offset:2304
  ds_read_b128 v[180:183], v85 offset:768
  ds_read_b128 v[120:123], v84 offset:18432
  ds_read_b128 v[192:195], v85 offset:6144
  ds_read_b128 v[132:135], v84 offset:20736
  ds_read_b128 v[204:207], v85 offset:6912
  ds_read_b128 v[144:147], v84 offset:36864
  ds_read_b128 v[216:219], v85 offset:12288
  ds_read_b128 v[156:159], v84 offset:39168
  ds_read_b128 v[228:231], v85 offset:13056
  s_waitcnt lgkmcnt(13)
  ds_read_b128 v[100:103], v84 offset:64
  ds_read_b128 v[172:175], v85 offset:64
  s_waitcnt lgkmcnt(13)
  ds_read_b128 v[112:115], v84 offset:2368
  ds_read_b128 v[184:187], v85 offset:832
  s_waitcnt lgkmcnt(13)
  ds_read_b128 v[124:127], v84 offset:18496
  ds_read_b128 v[196:199], v85 offset:6208
  s_waitcnt lgkmcnt(13)
  ds_read_b128 v[136:139], v84 offset:20800
  ds_read_b128 v[208:211], v85 offset:6976
  s_waitcnt lgkmcnt(13)
  ds_read_b128 v[148:151], v84 offset:36928
  ds_read_b128 v[220:223], v85 offset:12352
  s_waitcnt lgkmcnt(13)
  ds_read_b128 v[160:163], v84 offset:39232
  ds_read_b128 v[232:235], v85 offset:13120
  s_waitcnt lgkmcnt(13)
  ds_read_b128 v[104:107], v84 offset:128
  ds_read_b128 v[176:179], v85 offset:128
  s_waitcnt lgkmcnt(13)
  ds_read_b128 v[116:119], v84 offset:2432
  ds_read_b128 v[188:191], v85 offset:896
  s_waitcnt lgkmcnt(13)
  ds_read_b128 v[128:131], v84 offset:18560
  ds_read_b128 v[200:203], v85 offset:6272
  s_waitcnt lgkmcnt(13)
  ds_read_b128 v[140:143], v84 offset:20864
  ds_read_b128 v[212:215], v85 offset:7040
  s_waitcnt lgkmcnt(13)
  ds_read_b128 v[152:155], v84 offset:36992
  ds_read_b128 v[224:227], v85 offset:12416
  s_waitcnt lgkmcnt(13)
  ds_read_b128 v[164:167], v84 offset:39296
  ds_read_b128 v[236:239], v85 offset:13184
main_r1:
  s_waitcnt lgkmcnt(0)
  s_barrier

  s_cmp_eq_u32 s18, 6
  s_cbranch_scc1 main_f1
  s_cmp_eq_u32 s20, 3
  s_cbranch_scc1 main_fV
  s_cmp_ge_u32 s18, 3
  s_cbranch_scc1 main_fW
  s_mov_b32 s62, s43
  s_mov_b32 s63, s43
  s_add_u32 m0, s45, 0
  s_add_u32 s24, s22, 0
  s_mov_b32 exec_hi, 0xffff
  buffer_load_dwordx4 v3, s[4:7], s24 offen nt lds
  s_mov_b32 exec_hi, -1
  v_mfma_f32_16x16x32_bf16 v[24:27], v[96:99], v[168:171], 0
  v_mfma_f32_16x16x32_bf16 v[28:31], v[108:111], v[168:171], 0
  v_mfma_f32_16x16x32_bf16 v[32:35], v[120:123], v[168:171], 0
  v_mfma_f32_16x16x32_bf16 v[36:39], v[132:135], v[168:171], 0
  v_mfma_f32_16x16x32_bf16 v[40:43], v[144:147], v[168:171], 0
  v_mfma_f32_16x16x32_bf16 v[44:47], v[156:159], v[168:171], 0
  v_mfma_f32_16x16x32_bf16 v[24:27], v[100:103], v[172:175], v[24:27]
  v_mfma_f32_16x16x32_bf16 v[28:31], v[112:115], v[172:175], v[28:31]
  v_mfma_f32_16x16x32_bf16 v[32:35], v[124:127], v[172:175], v[32:35]
  v_mfma_f32_16x16x32_bf16 v[36:39], v[136:139], v[172:175], v[36:39]
  v_mfma_f32_16x16x32_bf16 v[40:43], v[148:151], v[172:175], v[40:43]
  v_mfma_f32_16x16x32_bf16 v[44:47], v[160:163], v[172:175], v[44:47]
  v_mfma_f32_16x16x32_bf16 v[24:27], v[104:107], v[176:179], v[24:27]
  s_add_u32 m0, s45, 784
  s_add_u32 s24, s22, 50135232
  s_mov_b32 exec_hi, 0xffff
  buffer_load_dwordx4 v3, s[4:7], s24 offen nt lds
  s_mov_b32 exec_hi, -1
  v_mfma_f32_16x16x32_bf16 v[28:31], v[116:119], v[176:179], v[28:31]
  v_mfma_f32_16x16x32_bf16 v[32:35], v[128:131], v[176:179], v[32:35]
  v_mfma_f32_16x16x32_bf16 v[36:39], v[140:143], v[176:179], v[36:39]
  v_mfma_f32_16x16x32_bf16 v[40:43], v[152:155], v[176:179], v[40:43]
  v_mfma_f32_16x16x32_bf16 v[44:47], v[164:167], v[176:179], v[44:47]
  s_nop 1
  v_pk_add_f32 v[84:85], v[24:25], v[26:27]
  v_mfma_f32_16x16x32_bf16 v[48:51], v[96:99], v[180:183], 0
  v_pk_add_f32 v[84:85], v[84:85], v[28:29]
  v_pk_add_f32 v[84:85], v[84:85], v[30:31]
  v_mfma_f32_16x16x32_bf16 v[52:55], v[108:111], v[180:183], 0
  v_pk_add_f32 v[84:85], v[84:85], v[32:33]
  v_pk_add_f32 v[84:85], v[84:85], v[34:35]
  v_mfma_f32_16x16x32_bf16 v[56:59], v[120:123], v[180:183], 0
  v_pk_add_f32 v[84:85], v[84:85], v[36:37]
  v_pk_add_f32 v[84:85], v[84:85], v[38:39]
  v_mfma_f32_16x16x32_bf16 v[60:63], v[132:135], v[180:183], 0
  v_pk_add_f32 v[84:85], v[84:85], v[40:41]
  v_pk_add_f32 v[84:85], v[84:85], v[42:43]
  v_mfma_f32_16x16x32_bf16 v[64:67], v[144:147], v[180:183], 0
  v_pk_add_f32 v[84:85], v[84:85], v[44:45]
  v_pk_add_f32 v[84:85], v[84:85], v[46:47]
  v_mfma_f32_16x16x32_bf16 v[68:71], v[156:159], v[180:183], 0
  s_add_u32 m0, s45, 1568
  s_add_u32 s24, s22, 100270464
  s_mov_b32 exec_hi, 0xffff
  buffer_load_dwordx4 v3, s[4:7], s24 offen nt lds
  s_mov_b32 exec_hi, -1
  v_add_f32 v84, v84, v85
  v_mfma_f32_16x16x32_bf16 v[48:51], v[100:103], v[184:187], v[48:51]
  v_mov_b32 v85, v84
  v_mfma_f32_16x16x32_bf16 v[52:55], v[112:115], v[184:187], v[52:55]
  s_nop 0
  v_permlane32_swap_b32 v84, v85
  v_mfma_f32_16x16x32_bf16 v[56:59], v[124:127], v[184:187], v[56:59]
  v_add_f32 v84, v84, v85
  v_mov_b32 v85, v84
  v_mfma_f32_16x16x32_bf16 v[60:63], v[136:139], v[184:187], v[60:63]
  s_nop 0
  v_permlane16_swap_b32 v84, v85
  v_mfma_f32_16x16x32_bf16 v[64:67], v[148:151], v[184:187], v[64:67]
  v_add_f32 v84, v84, v85
  v_mul_f32 v85, s26, v84
  v_mfma_f32_16x16x32_bf16 v[68:71], v[160:163], v[184:187], v[68:71]
  v_mul_f32 v84, s26, v84
  v_pk_fma_f32 v[24:25], v[24:25], s[28:29], v[84:85]
  v_mfma_f32_16x16x32_bf16 v[48:51], v[104:107], v[188:191], v[48:51]
  v_pk_fma_f32 v[26:27], v[26:27], s[28:29], v[84:85]
  v_pk_fma_f32 v[28:29], v[28:29], s[28:29], v[84:85]
  v_mfma_f32_16x16x32_bf16 v[52:55], v[116:119], v[188:191], v[52:55]
  v_pk_fma_f32 v[30:31], v[30:31], s[28:29], v[84:85]
  v_pk_fma_f32 v[32:33], v[32:33], s[28:29], v[84:85]
  v_mfma_f32_16x16x32_bf16 v[56:59], v[128:131], v[188:191], v[56:59]
  v_pk_fma_f32 v[34:35], v[34:35], s[28:29], v[84:85]
  v_pk_fma_f32 v[36:37], v[36:37], s[28:29], v[84:85]
  v_mfma_f32_16x16x32_bf16 v[60:63], v[140:143], v[188:191], v[60:63]
  v_pk_fma_f32 v[38:39], v[38:39], s[28:29], v[84:85]
  v_pk_fma_f32 v[40:41], v[40:41], s[28:29], v[84:85]
  v_mfma_f32_16x16x32_bf16 v[64:67], v[152:155], v[188:191], v[64:67]
  v_pk_fma_f32 v[42:43], v[42:43], s[28:29], v[84:85]
  s_add_u32 m0, s45, 2352
  s_add_u32 s24, s22, 150405696
  s_mov_b32 exec_hi, 0xffff
  buffer_load_dwordx4 v3, s[4:7], s24 offen nt lds
  s_mov_b32 exec_hi, -1
  v_mfma_f32_16x16x32_bf16 v[68:71], v[164:167], v[188:191], v[68:71]
  v_pk_fma_f32 v[44:45], v[44:45], s[28:29], v[84:85]
  v_pk_fma_f32 v[46:47], v[46:47], s[28:29], v[84:85]
  v_mfma_f32_16x16x32_bf16 v[240:243], v[96:99], v[192:195], 0
  v_pk_add_f32 v[86:87], v[48:49], v[50:51]
  v_pk_add_f32 v[86:87], v[86:87], v[52:53]
  v_mfma_f32_16x16x32_bf16 v[244:247], v[108:111], v[192:195], 0
  v_pk_add_f32 v[86:87], v[86:87], v[54:55]
  v_pk_add_f32 v[86:87], v[86:87], v[56:57]
  v_mfma_f32_16x16x32_bf16 v[248:251], v[120:123], v[192:195], 0
  v_pk_add_f32 v[86:87], v[86:87], v[58:59]
  v_pk_add_f32 v[86:87], v[86:87], v[60:61]
  v_mfma_f32_16x16x32_bf16 v[252:255], v[132:135], v[192:195], 0
  v_pk_add_f32 v[86:87], v[86:87], v[62:63]
  v_pk_add_f32 v[86:87], v[86:87], v[64:65]
  v_mfma_f32_16x16x32_bf16 v[168:171], v[144:147], v[192:195], 0
  v_pk_add_f32 v[86:87], v[86:87], v[66:67]
  v_pk_add_f32 v[86:87], v[86:87], v[68:69]
  v_mfma_f32_16x16x32_bf16 v[172:175], v[156:159], v[192:195], 0
  v_pk_add_f32 v[86:87], v[86:87], v[70:71]
  v_add_f32 v86, v86, v87
  v_mfma_f32_16x16x32_bf16 v[240:243], v[100:103], v[196:199], v[240:243]
  v_mov_b32 v87, v86
  v_mfma_f32_16x16x32_bf16 v[244:247], v[112:115], v[196:199], v[244:247]
  s_nop 0
  v_permlane32_swap_b32 v86, v87
  v_mfma_f32_16x16x32_bf16 v[248:251], v[124:127], v[196:199], v[248:251]
  v_add_f32 v86, v86, v87
  v_mov_b32 v87, v86
  v_mfma_f32_16x16x32_bf16 v[252:255], v[136:139], v[196:199], v[252:255]
  s_add_u32 m0, s45, 3152
  s_add_u32 s24, s22, 0
  s_mov_b32 exec_hi, 0xffff
  buffer_load_dwordx4 v4, s[4:7], s24 offen nt lds
  s_mov_b32 exec_hi, -1
  v_permlane16_swap_b32 v86, v87
  v_mfma_f32_16x16x32_bf16 v[168:171], v[148:151], v[196:199], v[168:171]
  v_add_f32 v86, v86, v87
  v_mul_f32 v87, s26, v86
  v_mfma_f32_16x16x32_bf16 v[172:175], v[160:163], v[196:199], v[172:175]
  v_mul_f32 v86, s26, v86
  v_pk_fma_f32 v[48:49], v[48:49], s[28:29], v[86:87]
  v_mfma_f32_16x16x32_bf16 v[240:243], v[104:107], v[200:203], v[240:243]
  v_pk_fma_f32 v[50:51], v[50:51], s[28:29], v[86:87]
  v_pk_fma_f32 v[52:53], v[52:53], s[28:29], v[86:87]
  v_mfma_f32_16x16x32_bf16 v[244:247], v[116:119], v[200:203], v[244:247]
  v_pk_fma_f32 v[54:55], v[54:55], s[28:29], v[86:87]
  v_pk_fma_f32 v[56:57], v[56:57], s[28:29], v[86:87]
  v_mfma_f32_16x16x32_bf16 v[248:251], v[128:131], v[200:203], v[248:251]
  v_pk_fma_f32 v[58:59], v[58:59], s[28:29], v[86:87]
  v_pk_fma_f32 v[60:61], v[60:61], s[28:29], v[86:87]
  v_mfma_f32_16x16x32_bf16 v[252:255], v[140:143], v[200:203], v[252:255]
  v_pk_fma_f32 v[62:63], v[62:63], s[28:29], v[86:87]
  v_pk_fma_f32 v[64:65], v[64:65], s[28:29], v[86:87]
  v_mfma_f32_16x16x32_bf16 v[168:171], v[152:155], v[200:203], v[168:171]
  v_pk_fma_f32 v[66:67], v[66:67], s[28:29], v[86:87]
  v_pk_fma_f32 v[68:69], v[68:69], s[28:29], v[86:87]
  v_mfma_f32_16x16x32_bf16 v[172:175], v[164:167], v[200:203], v[172:175]
  v_pk_fma_f32 v[70:71], v[70:71], s[28:29], v[86:87]
  v_pk_add_f32 v[84:85], v[240:241], v[242:243]
  v_mfma_f32_16x16x32_bf16 v[176:179], v[96:99], v[204:207], 0
  v_pk_add_f32 v[84:85], v[84:85], v[244:245]
  v_pk_add_f32 v[84:85], v[84:85], v[246:247]
  v_mfma_f32_16x16x32_bf16 v[180:183], v[108:111], v[204:207], 0
  v_pk_add_f32 v[84:85], v[84:85], v[248:249]
  v_pk_add_f32 v[84:85], v[84:85], v[250:251]
  v_mfma_f32_16x16x32_bf16 v[184:187], v[120:123], v[204:207], 0
  v_pk_add_f32 v[84:85], v[84:85], v[252:253]
  s_add_u32 m0, s45, 3936
  s_add_u32 s24, s22, 50135232
  s_mov_b32 exec_hi, 0xffff
  buffer_load_dwordx4 v4, s[4:7], s24 offen nt lds
  s_mov_b32 exec_hi, -1
  v_mfma_f32_16x16x32_bf16 v[188:191], v[132:135], v[204:207], 0
  v_pk_add_f32 v[84:85], v[84:85], v[254:255]
  v_pk_add_f32 v[84:85], v[84:85], v[168:169]
  v_mfma_f32_16x16x32_bf16 v[192:195], v[144:147], v[204:207], 0
  v_pk_add_f32 v[84:85], v[84:85], v[170:171]
  v_pk_add_f32 v[84:85], v[84:85], v[172:173]
  v_mfma_f32_16x16x32_bf16 v[196:199], v[156:159], v[204:207], 0
  v_pk_add_f32 v[84:85], v[84:85], v[174:175]
  v_add_f32 v84, v84, v85
  v_mfma_f32_16x16x32_bf16 v[176:179], v[100:103], v[208:211], v[176:179]
  v_mov_b32 v85, v84
  v_mfma_f32_16x16x32_bf16 v[180:183], v[112:115], v[208:211], v[180:183]
  s_nop 0
  v_permlane32_swap_b32 v84, v85
  v_mfma_f32_16x16x32_bf16 v[184:187], v[124:127], v[208:211], v[184:187]
  v_add_f32 v84, v84, v85
  v_mov_b32 v85, v84
  v_mfma_f32_16x16x32_bf16 v[188:191], v[136:139], v[208:211], v[188:191]
  s_nop 0
  v_permlane16_swap_b32 v84, v85
  v_mfma_f32_16x16x32_bf16 v[192:195], v[148:151], v[208:211], v[192:195]
  v_add_f32 v84, v84, v85
  v_mul_f32 v85, s26, v84
  v_mfma_f32_16x16x32_bf16 v[196:199], v[160:163], v[208:211], v[196:199]
  v_mul_f32 v84, s26, v84
  v_pk_fma_f32 v[240:241], v[240:241], s[28:29], v[84:85]
  v_mfma_f32_16x16x32_bf16 v[176:179], v[104:107], v[212:215], v[176:179]
  v_pk_fma_f32 v[242:243], v[242:243], s[28:29], v[84:85]
  v_pk_fma_f32 v[244:245], v[244:245], s[28:29], v[84:85]
  v_mfma_f32_16x16x32_bf16 v[180:183], v[116:119], v[212:215], v[180:183]
  s_add_u32 m0, s45, 4720
  s_add_u32 s24, s22, 100270464
  s_mov_b32 exec_hi, 0xffff
  buffer_load_dwordx4 v4, s[4:7], s24 offen nt lds
  s_mov_b32 exec_hi, -1
  v_pk_fma_f32 v[246:247], v[246:247], s[28:29], v[84:85]
  v_mfma_f32_16x16x32_bf16 v[184:187], v[128:131], v[212:215], v[184:187]
  v_pk_fma_f32 v[248:249], v[248:249], s[28:29], v[84:85]
  v_pk_fma_f32 v[250:251], v[250:251], s[28:29], v[84:85]
  v_mfma_f32_16x16x32_bf16 v[188:191], v[140:143], v[212:215], v[188:191]
  v_pk_fma_f32 v[252:253], v[252:253], s[28:29], v[84:85]
  v_pk_fma_f32 v[254:255], v[254:255], s[28:29], v[84:85]
  v_mfma_f32_16x16x32_bf16 v[192:195], v[152:155], v[212:215], v[192:195]
  v_pk_fma_f32 v[168:169], v[168:169], s[28:29], v[84:85]
  v_pk_fma_f32 v[170:171], v[170:171], s[28:29], v[84:85]
  v_mfma_f32_16x16x32_bf16 v[196:199], v[164:167], v[212:215], v[196:199]
  v_pk_fma_f32 v[172:173], v[172:173], s[28:29], v[84:85]
  v_pk_fma_f32 v[174:175], v[174:175], s[28:29], v[84:85]
  v_mfma_f32_16x16x32_bf16 v[200:203], v[96:99], v[216:219], 0
  v_pk_add_f32 v[86:87], v[176:177], v[178:179]
  v_pk_add_f32 v[86:87], v[86:87], v[180:181]
  v_mfma_f32_16x16x32_bf16 v[204:207], v[96:99], v[228:231], 0
  v_pk_add_f32 v[86:87], v[86:87], v[182:183]
  v_pk_add_f32 v[86:87], v[86:87], v[184:185]
  v_mfma_f32_16x16x32_bf16 v[200:203], v[100:103], v[220:223], v[200:203]
  v_pk_add_f32 v[86:87], v[86:87], v[186:187]
  v_pk_add_f32 v[86:87], v[86:87], v[188:189]
  v_mfma_f32_16x16x32_bf16 v[204:207], v[100:103], v[232:235], v[204:207]
  v_pk_add_f32 v[86:87], v[86:87], v[190:191]
  v_pk_add_f32 v[86:87], v[86:87], v[192:193]
  v_mfma_f32_16x16x32_bf16 v[200:203], v[104:107], v[224:227], v[200:203]
  v_pk_add_f32 v[86:87], v[86:87], v[194:195]
  v_pk_add_f32 v[86:87], v[86:87], v[196:197]
  v_mfma_f32_16x16x32_bf16 v[204:207], v[104:107], v[236:239], v[204:207]
  v_pk_add_f32 v[86:87], v[86:87], v[198:199]
  v_pk_add_f32 v[104:105], v[24:25], v[48:49]
  v_mfma_f32_16x16x32_bf16 v[208:211], v[108:111], v[216:219], 0
  v_add_f32 v86, v86, v87
  s_add_u32 m0, s45, 5504
  s_add_u32 s24, s22, 150405696
  s_mov_b32 exec_hi, 0xffff
  buffer_load_dwordx4 v4, s[4:7], s24 offen nt lds
  s_mov_b32 exec_hi, -1
  v_mfma_f32_16x16x32_bf16 v[212:215], v[108:111], v[228:231], 0
  v_mov_b32 v87, v86
  v_pk_add_f32 v[104:105], v[104:105], v[240:241]
  v_mfma_f32_16x16x32_bf16 v[208:211], v[112:115], v[220:223], v[208:211]
  v_permlane32_swap_b32 v86, v87
  v_mfma_f32_16x16x32_bf16 v[212:215], v[112:115], v[232:235], v[212:215]
  v_add_f32 v86, v86, v87
  v_pk_add_f32 v[106:107], v[26:27], v[50:51]
  v_mfma_f32_16x16x32_bf16 v[208:211], v[116:119], v[224:227], v[208:211]
  v_mov_b32 v87, v86
  v_pk_add_f32 v[106:107], v[106:107], v[242:243]
  v_mfma_f32_16x16x32_bf16 v[212:215], v[116:119], v[236:239], v[212:215]
  v_permlane16_swap_b32 v86, v87
  v_mfma_f32_16x16x32_bf16 v[96:99], v[120:123], v[216:219], 0
  v_add_f32 v86, v86, v87
  v_pk_add_f32 v[116:117], v[28:29], v[52:53]
  v_mfma_f32_16x16x32_bf16 v[100:103], v[120:123], v[228:231], 0
  v_mul_f32 v87, s26, v86
  v_mul_f32 v86, s26, v86
  v_mfma_f32_16x16x32_bf16 v[96:99], v[124:127], v[220:223], v[96:99]
  v_pk_fma_f32 v[176:177], v[176:177], s[28:29], v[86:87]
  v_pk_fma_f32 v[178:179], v[178:179], s[28:29], v[86:87]
  v_mfma_f32_16x16x32_bf16 v[100:103], v[124:127], v[232:235], v[100:103]
  v_pk_fma_f32 v[180:181], v[180:181], s[28:29], v[86:87]
  v_pk_fma_f32 v[182:183], v[182:183], s[28:29], v[86:87]
  v_mfma_f32_16x16x32_bf16 v[96:99], v[128:131], v[224:227], v[96:99]
  v_pk_fma_f32 v[184:185], v[184:185], s[28:29], v[86:87]
  v_pk_fma_f32 v[186:187], v[186:187], s[28:29], v[86:87]
  v_mfma_f32_16x16x32_bf16 v[100:103], v[128:131], v[236:239], v[100:103]
  v_pk_fma_f32 v[188:189], v[188:189], s[28:29], v[86:87]
  v_pk_fma_f32 v[190:191], v[190:191], s[28:29], v[86:87]
  v_mfma_f32_16x16x32_bf16 v[108:111], v[132:135], v[216:219], 0
  v_pk_fma_f32 v[192:193], v[192:193], s[28:29], v[86:87]
  v_pk_fma_f32 v[194:195], v[194:195], s[28:29], v[86:87]
  v_mfma_f32_16x16x32_bf16 v[112:115], v[132:135], v[228:231], 0
  s_add_u32 m0, s45, 6304
  s_add_u32 s24, s22, 0
  s_mov_b32 exec_hi, 0xffff
  buffer_load_dwordx4 v5, s[4:7], s24 offen nt lds
  s_mov_b32 exec_hi, -1
  v_pk_fma_f32 v[196:197], v[196:197], s[28:29], v[86:87]
  v_mfma_f32_16x16x32_bf16 v[108:111], v[136:139], v[220:223], v[108:111]
  v_pk_fma_f32 v[198:199], v[198:199], s[28:29], v[86:87]
  v_pk_add_f32 v[104:105], v[104:105], v[176:177]
  v_mfma_f32_16x16x32_bf16 v[112:115], v[136:139], v[232:235], v[112:115]
  v_pk_add_f32 v[106:107], v[106:107], v[178:179]
  v_pk_add_f32 v[116:117], v[116:117], v[244:245]
  v_mfma_f32_16x16x32_bf16 v[108:111], v[140:143], v[224:227], v[108:111]
  v_pk_add_f32 v[116:117], v[116:117], v[180:181]
  v_pk_add_f32 v[118:119], v[30:31], v[54:55]
  v_mfma_f32_16x16x32_bf16 v[112:115], v[140:143], v[236:239], v[112:115]
  v_pk_add_f32 v[118:119], v[118:119], v[246:247]
  v_pk_add_f32 v[128:129], v[32:33], v[56:57]
  v_mfma_f32_16x16x32_bf16 v[120:123], v[144:147], v[216:219], 0
  v_pk_add_f32 v[118:119], v[118:119], v[182:183]
  v_pk_add_f32 v[128:129], v[128:129], v[248:249]
  v_mfma_f32_16x16x32_bf16 v[124:127], v[144:147], v[228:231], 0
  v_pk_add_f32 v[128:129], v[128:129], v[184:185]
  v_pk_add_f32 v[130:131], v[34:35], v[58:59]
  v_mfma_f32_16x16x32_bf16 v[120:123], v[148:151], v[220:223], v[120:123]
  v_pk_add_f32 v[130:131], v[130:131], v[250:251]
  v_pk_add_f32 v[140:141], v[36:37], v[60:61]
  v_mfma_f32_16x16x32_bf16 v[124:127], v[148:151], v[232:235], v[124:127]
  v_pk_add_f32 v[130:131], v[130:131], v[186:187]
  v_pk_add_f32 v[140:141], v[140:141], v[252:253]
  v_mfma_f32_16x16x32_bf16 v[120:123], v[152:155], v[224:227], v[120:123]
  v_pk_add_f32 v[140:141], v[140:141], v[188:189]
  v_pk_add_f32 v[142:143], v[38:39], v[62:63]
  v_mfma_f32_16x16x32_bf16 v[124:127], v[152:155], v[236:239], v[124:127]
  v_pk_add_f32 v[142:143], v[142:143], v[254:255]
  v_pk_add_f32 v[152:153], v[40:41], v[64:65]
  v_mfma_f32_16x16x32_bf16 v[132:135], v[156:159], v[216:219], 0
  v_pk_add_f32 v[142:143], v[142:143], v[190:191]
  v_pk_add_f32 v[152:153], v[152:153], v[168:169]
  v_mfma_f32_16x16x32_bf16 v[136:139], v[156:159], v[228:231], 0
  v_pk_add_f32 v[152:153], v[152:153], v[192:193]
  v_pk_add_f32 v[154:155], v[42:43], v[66:67]
  s_add_u32 m0, s45, 7088
  s_add_u32 s24, s22, 50135232
  s_mov_b32 exec_hi, 0xffff
  buffer_load_dwordx4 v5, s[4:7], s24 offen nt lds
  s_mov_b32 exec_hi, -1
  v_mfma_f32_16x16x32_bf16 v[132:135], v[160:163], v[220:223], v[132:135]
  v_pk_add_f32 v[154:155], v[154:155], v[170:171]
  v_pk_add_f32 v[84:85], v[200:201], v[202:203]
  v_mfma_f32_16x16x32_bf16 v[136:139], v[160:163], v[232:235], v[136:139]
  v_pk_add_f32 v[154:155], v[154:155], v[194:195]
  v_pk_add_f32 v[84:85], v[84:85], v[208:209]
  v_mfma_f32_16x16x32_bf16 v[132:135], v[164:167], v[224:227], v[132:135]
  v_pk_add_f32 v[84:85], v[84:85], v[210:211]
  v_pk_add_f32 v[86:87], v[204:205], v[206:207]
  v_mfma_f32_16x16x32_bf16 v[136:139], v[164:167], v[236:239], v[136:139]
  v_pk_add_f32 v[164:165], v[44:45], v[68:69]
  v_pk_add_f32 v[166:167], v[46:47], v[70:71]
  v_pk_add_f32 v[164:165], v[164:165], v[172:173]
  v_pk_add_f32 v[166:167], v[166:167], v[174:175]
  v_pk_add_f32 v[164:165], v[164:165], v[196:197]
  v_pk_add_f32 v[166:167], v[166:167], v[198:199]
  v_pk_add_f32 v[84:85], v[84:85], v[96:97]
  v_pk_add_f32 v[86:87], v[86:87], v[212:213]
  v_pk_add_f32 v[84:85], v[84:85], v[98:99]
  v_pk_add_f32 v[86:87], v[86:87], v[214:215]
  v_pk_add_f32 v[84:85], v[84:85], v[108:109]
  v_pk_add_f32 v[86:87], v[86:87], v[100:101]
  v_pk_add_f32 v[84:85], v[84:85], v[110:111]
  v_pk_add_f32 v[86:87], v[86:87], v[102:103]
  v_pk_add_f32 v[84:85], v[84:85], v[120:121]
  v_pk_add_f32 v[86:87], v[86:87], v[112:113]
  v_pk_add_f32 v[84:85], v[84:85], v[122:123]
  v_pk_add_f32 v[86:87], v[86:87], v[114:115]
  v_pk_add_f32 v[84:85], v[84:85], v[132:133]
  v_pk_add_f32 v[86:87], v[86:87], v[124:125]
  v_pk_add_f32 v[84:85], v[84:85], v[134:135]
  v_pk_add_f32 v[86:87], v[86:87], v[126:127]
  v_add_f32 v84, v84, v85
  v_pk_add_f32 v[86:87], v[86:87], v[136:137]
  v_mov_b32 v85, v84
  v_pk_add_f32 v[86:87], v[86:87], v[138:139]
  s_nop 0
  v_permlane32_swap_b32 v84, v85
  v_add_f32 v86, v86, v87
  v_add_f32 v84, v84, v85
  v_mov_b32 v87, v86
  v_mov_b32 v85, v84
  s_nop 0
  v_permlane32_swap_b32 v86, v87
  s_add_u32 m0, s45, 7872
  s_add_u32 s24, s22, 100270464
  s_mov_b32 exec_hi, 0xffff
  buffer_load_dwordx4 v5, s[4:7], s24 offen nt lds
  s_mov_b32 exec_hi, -1
  v_permlane16_swap_b32 v84, v85
  v_add_f32 v86, v86, v87
  v_add_f32 v84, v84, v85
  v_mov_b32 v87, v86
  v_mul_f32 v85, s26, v84
  v_mul_f32 v84, s26, v84
  v_permlane16_swap_b32 v86, v87
  v_pk_fma_f32 v[200:201], v[200:201], s[28:29], v[84:85]
  v_pk_fma_f32 v[202:203], v[202:203], s[28:29], v[84:85]
  v_pk_fma_f32 v[208:209], v[208:209], s[28:29], v[84:85]
  v_pk_fma_f32 v[210:211], v[210:211], s[28:29], v[84:85]
  v_pk_fma_f32 v[96:97], v[96:97], s[28:29], v[84:85]
  v_pk_fma_f32 v[98:99], v[98:99], s[28:29], v[84:85]
  v_pk_fma_f32 v[108:109], v[108:109], s[28:29], v[84:85]
  v_pk_fma_f32 v[110:111], v[110:111], s[28:29], v[84:85]
  v_pk_fma_f32 v[120:121], v[120:121], s[28:29], v[84:85]
  v_pk_fma_f32 v[122:123], v[122:123], s[28:29], v[84:85]
  v_pk_fma_f32 v[132:133], v[132:133], s[28:29], v[84:85]
  v_pk_fma_f32 v[134:135], v[134:135], s[28:29], v[84:85]
  v_add_f32 v86, v86, v87
  v_pk_add_f32 v[104:105], v[104:105], v[200:201]
  v_mul_f32 v87, s26, v86
  v_mul_f32 v86, s26, v86
  v_pk_add_f32 v[106:107], v[106:107], v[202:203]
  v_pk_fma_f32 v[204:205], v[204:205], s[28:29], v[86:87]
  v_pk_fma_f32 v[206:207], v[206:207], s[28:29], v[86:87]
  v_pk_fma_f32 v[212:213], v[212:213], s[28:29], v[86:87]
  v_pk_fma_f32 v[214:215], v[214:215], s[28:29], v[86:87]
  v_pk_fma_f32 v[100:101], v[100:101], s[28:29], v[86:87]
  v_pk_fma_f32 v[102:103], v[102:103], s[28:29], v[86:87]
  v_pk_fma_f32 v[112:113], v[112:113], s[28:29], v[86:87]
  v_pk_fma_f32 v[114:115], v[114:115], s[28:29], v[86:87]
  v_pk_fma_f32 v[124:125], v[124:125], s[28:29], v[86:87]
  v_pk_fma_f32 v[126:127], v[126:127], s[28:29], v[86:87]
  v_pk_fma_f32 v[136:137], v[136:137], s[28:29], v[86:87]
  v_pk_fma_f32 v[138:139], v[138:139], s[28:29], v[86:87]
  v_pk_add_f32 v[104:105], v[104:105], v[204:205]
  v_pk_add_f32 v[106:107], v[106:107], v[206:207]
  v_pk_add_f32 v[116:117], v[116:117], v[208:209]
  v_add_f32_dpp v104, v104, v104 row_ror:8 row_mask:0xf bank_mask:0xf
  v_add_f32_dpp v105, v105, v105 row_ror:8 row_mask:0xf bank_mask:0xf
  v_add_f32_dpp v106, v106, v106 row_ror:8 row_mask:0xf bank_mask:0xf
  v_add_f32_dpp v107, v107, v107 row_ror:8 row_mask:0xf bank_mask:0xf
  v_add_f32_dpp v104, v104, v104 row_ror:4 row_mask:0xf bank_mask:0xf
  v_add_f32_dpp v105, v105, v105 row_ror:4 row_mask:0xf bank_mask:0xf
  v_add_f32_dpp v106, v106, v106 row_ror:4 row_mask:0xf bank_mask:0xf
  v_add_f32_dpp v107, v107, v107 row_ror:4 row_mask:0xf bank_mask:0xf
  s_add_u32 m0, s45, 8656
  s_add_u32 s24, s22, 150405696
  s_mov_b32 exec_hi, 0xffff
  buffer_load_dwordx4 v5, s[4:7], s24 offen nt lds
  s_mov_b32 exec_hi, -1
  v_add_f32_dpp v104, v104, v104 row_ror:2 row_mask:0xf bank_mask:0xf
  v_add_f32_dpp v105, v105, v105 row_ror:2 row_mask:0xf bank_mask:0xf
  v_add_f32_dpp v106, v106, v106 row_ror:2 row_mask:0xf bank_mask:0xf
  v_add_f32_dpp v107, v107, v107 row_ror:2 row_mask:0xf bank_mask:0xf
  v_add_f32_dpp v104, v104, v104 row_ror:1 row_mask:0xf bank_mask:0xf
  v_add_f32_dpp v105, v105, v105 row_ror:1 row_mask:0xf bank_mask:0xf
  v_add_f32_dpp v106, v106, v106 row_ror:1 row_mask:0xf bank_mask:0xf
  v_add_f32_dpp v107, v107, v107 row_ror:1 row_mask:0xf bank_mask:0xf
  v_pk_fma_f32 v[24:25], v[104:105], s[62:63], v[24:25]
  v_pk_fma_f32 v[26:27], v[106:107], s[62:63], v[26:27]
  v_pk_fma_f32 v[48:49], v[104:105], s[62:63], v[48:49]
  v_pk_fma_f32 v[50:51], v[106:107], s[62:63], v[50:51]
  v_pk_fma_f32 v[240:241], v[104:105], s[62:63], v[240:241]
  v_pk_fma_f32 v[242:243], v[106:107], s[62:63], v[242:243]
  v_pk_fma_f32 v[176:177], v[104:105], s[62:63], v[176:177]
  v_pk_fma_f32 v[178:179], v[106:107], s[62:63], v[178:179]
  v_pk_fma_f32 v[200:201], v[104:105], s[62:63], v[200:201]
  v_pk_fma_f32 v[202:203], v[106:107], s[62:63], v[202:203]
  v_pk_fma_f32 v[204:205], v[104:105], s[62:63], v[204:205]
  v_pk_fma_f32 v[206:207], v[106:107], s[62:63], v[206:207]
  v_pk_add_f32 v[116:117], v[116:117], v[212:213]
  v_pk_add_f32 v[118:119], v[118:119], v[210:211]
  v_cvt_pk_bf16_f32 v24, v24, v25
  v_pk_add_f32 v[118:119], v[118:119], v[214:215]
  v_add_f32_dpp v116, v116, v116 row_ror:8 row_mask:0xf bank_mask:0xf
  v_add_f32_dpp v117, v117, v117 row_ror:8 row_mask:0xf bank_mask:0xf
  v_add_f32_dpp v118, v118, v118 row_ror:8 row_mask:0xf bank_mask:0xf
  v_add_f32_dpp v119, v119, v119 row_ror:8 row_mask:0xf bank_mask:0xf
  v_add_f32_dpp v116, v116, v116 row_ror:4 row_mask:0xf bank_mask:0xf
  v_add_f32_dpp v117, v117, v117 row_ror:4 row_mask:0xf bank_mask:0xf
  v_add_f32_dpp v118, v118, v118 row_ror:4 row_mask:0xf bank_mask:0xf
  v_add_f32_dpp v119, v119, v119 row_ror:4 row_mask:0xf bank_mask:0xf
  v_add_f32_dpp v116, v116, v116 row_ror:2 row_mask:0xf bank_mask:0xf
  v_add_f32_dpp v117, v117, v117 row_ror:2 row_mask:0xf bank_mask:0xf
  v_add_f32_dpp v118, v118, v118 row_ror:2 row_mask:0xf bank_mask:0xf
  v_add_f32_dpp v119, v119, v119 row_ror:2 row_mask:0xf bank_mask:0xf
  v_add_f32_dpp v116, v116, v116 row_ror:1 row_mask:0xf bank_mask:0xf
  v_add_f32_dpp v117, v117, v117 row_ror:1 row_mask:0xf bank_mask:0xf
  v_add_f32_dpp v118, v118, v118 row_ror:1 row_mask:0xf bank_mask:0xf
  v_add_f32_dpp v119, v119, v119 row_ror:1 row_mask:0xf bank_mask:0xf
  v_pk_fma_f32 v[28:29], v[116:117], s[62:63], v[28:29]
  v_pk_fma_f32 v[30:31], v[118:119], s[62:63], v[30:31]
  v_cvt_pk_bf16_f32 v25, v26, v27
  v_cvt_pk_bf16_f32 v26, v28, v29
  v_cvt_pk_bf16_f32 v27, v30, v31
  v_pk_fma_f32 v[52:53], v[116:117], s[62:63], v[52:53]
  ds_write_b128 v88, v[24:27] offset:0
  v_pk_fma_f32 v[54:55], v[118:119], s[62:63], v[54:55]
  v_cvt_pk_bf16_f32 v48, v48, v49
  v_cvt_pk_bf16_f32 v49, v50, v51
  v_cvt_pk_bf16_f32 v50, v52, v53
  v_cvt_pk_bf16_f32 v51, v54, v55
  v_pk_fma_f32 v[244:245], v[116:117], s[62:63], v[244:245]
  ds_write_b128 v88, v[48:51] offset:3072
  v_pk_fma_f32 v[246:247], v[118:119], s[62:63], v[246:247]
  v_cvt_pk_bf16_f32 v240, v240, v241
  v_cvt_pk_bf16_f32 v241, v242, v243
  v_cvt_pk_bf16_f32 v242, v244, v245
  v_cvt_pk_bf16_f32 v243, v246, v247
  v_pk_fma_f32 v[180:181], v[116:117], s[62:63], v[180:181]
  ds_write_b128 v88, v[240:243] offset:6144
  v_pk_fma_f32 v[182:183], v[118:119], s[62:63], v[182:183]
  v_cvt_pk_bf16_f32 v176, v176, v177
  v_cvt_pk_bf16_f32 v177, v178, v179
  v_cvt_pk_bf16_f32 v178, v180, v181
  v_cvt_pk_bf16_f32 v179, v182, v183
  v_pk_fma_f32 v[208:209], v[116:117], s[62:63], v[208:209]
  ds_write_b128 v88, v[176:179] offset:9216
  v_pk_fma_f32 v[210:211], v[118:119], s[62:63], v[210:211]
  v_cvt_pk_bf16_f32 v200, v200, v201
  v_cvt_pk_bf16_f32 v201, v202, v203
  v_cvt_pk_bf16_f32 v202, v208, v209
  v_cvt_pk_bf16_f32 v203, v210, v211
  v_pk_fma_f32 v[212:213], v[116:117], s[62:63], v[212:213]
  ds_write_b128 v88, v[200:203] offset:12288
  v_pk_fma_f32 v[214:215], v[118:119], s[62:63], v[214:215]
  v_cvt_pk_bf16_f32 v204, v204, v205
  v_cvt_pk_bf16_f32 v205, v206, v207
  v_cvt_pk_bf16_f32 v206, v212, v213
  v_cvt_pk_bf16_f32 v207, v214, v215
  v_pk_add_f32 v[128:129], v[128:129], v[96:97]
  ds_write_b128 v89, v[204:207] offset:1024
  v_pk_add_f32 v[128:129], v[128:129], v[100:101]
  v_pk_add_f32 v[130:131], v[130:131], v[98:99]
  v_pk_add_f32 v[140:141], v[140:141], v[108:109]
  v_pk_add_f32 v[130:131], v[130:131], v[102:103]
  v_add_f32_dpp v128, v128, v128 row_ror:8 row_mask:0xf bank_mask:0xf
  v_add_f32_dpp v129, v129, v129 row_ror:8 row_mask:0xf bank_mask:0xf
  v_add_f32_dpp v130, v130, v130 row_ror:8 row_mask:0xf bank_mask:0xf
  v_add_f32_dpp v131, v131, v131 row_ror:8 row_mask:0xf bank_mask:0xf
  v_add_f32_dpp v128, v128, v128 row_ror:4 row_mask:0xf bank_mask:0xf
  v_add_f32_dpp v129, v129, v129 row_ror:4 row_mask:0xf bank_mask:0xf
  v_add_f32_dpp v130, v130, v130 row_ror:4 row_mask:0xf bank_mask:0xf
  v_add_f32_dpp v131, v131, v131 row_ror:4 row_mask:0xf bank_mask:0xf
  v_add_f32_dpp v128, v128, v128 row_ror:2 row_mask:0xf bank_mask:0xf
  v_add_f32_dpp v129, v129, v129 row_ror:2 row_mask:0xf bank_mask:0xf
  v_add_f32_dpp v130, v130, v130 row_ror:2 row_mask:0xf bank_mask:0xf
  v_add_f32_dpp v131, v131, v131 row_ror:2 row_mask:0xf bank_mask:0xf
  v_add_f32_dpp v128, v128, v128 row_ror:1 row_mask:0xf bank_mask:0xf
  v_add_f32_dpp v129, v129, v129 row_ror:1 row_mask:0xf bank_mask:0xf
  v_add_f32_dpp v130, v130, v130 row_ror:1 row_mask:0xf bank_mask:0xf
  v_add_f32_dpp v131, v131, v131 row_ror:1 row_mask:0xf bank_mask:0xf
  v_pk_fma_f32 v[32:33], v[128:129], s[62:63], v[32:33]
  v_pk_fma_f32 v[34:35], v[130:131], s[62:63], v[34:35]
  v_pk_fma_f32 v[56:57], v[128:129], s[62:63], v[56:57]
  v_pk_fma_f32 v[58:59], v[130:131], s[62:63], v[58:59]
  v_pk_fma_f32 v[248:249], v[128:129], s[62:63], v[248:249]
  v_pk_fma_f32 v[250:251], v[130:131], s[62:63], v[250:251]
  v_pk_fma_f32 v[184:185], v[128:129], s[62:63], v[184:185]
  v_pk_fma_f32 v[186:187], v[130:131], s[62:63], v[186:187]
  v_pk_fma_f32 v[96:97], v[128:129], s[62:63], v[96:97]
  v_pk_fma_f32 v[98:99], v[130:131], s[62:63], v[98:99]
  v_pk_fma_f32 v[100:101], v[128:129], s[62:63], v[100:101]
  v_pk_fma_f32 v[102:103], v[130:131], s[62:63], v[102:103]
  v_pk_add_f32 v[140:141], v[140:141], v[112:113]
  v_pk_add_f32 v[142:143], v[142:143], v[110:111]
  v_cvt_pk_bf16_f32 v32, v32, v33
  v_pk_add_f32 v[142:143], v[142:143], v[114:115]
  v_add_f32_dpp v140, v140, v140 row_ror:8 row_mask:0xf bank_mask:0xf
  v_add_f32_dpp v141, v141, v141 row_ror:8 row_mask:0xf bank_mask:0xf
  v_add_f32_dpp v142, v142, v142 row_ror:8 row_mask:0xf bank_mask:0xf
  v_add_f32_dpp v143, v143, v143 row_ror:8 row_mask:0xf bank_mask:0xf
  v_add_f32_dpp v140, v140, v140 row_ror:4 row_mask:0xf bank_mask:0xf
  v_add_f32_dpp v141, v141, v141 row_ror:4 row_mask:0xf bank_mask:0xf
  v_add_f32_dpp v142, v142, v142 row_ror:4 row_mask:0xf bank_mask:0xf
  v_add_f32_dpp v143, v143, v143 row_ror:4 row_mask:0xf bank_mask:0xf
  v_add_f32_dpp v140, v140, v140 row_ror:2 row_mask:0xf bank_mask:0xf
  v_add_f32_dpp v141, v141, v141 row_ror:2 row_mask:0xf bank_mask:0xf
  v_add_f32_dpp v142, v142, v142 row_ror:2 row_mask:0xf bank_mask:0xf
  v_add_f32_dpp v143, v143, v143 row_ror:2 row_mask:0xf bank_mask:0xf
  v_add_f32_dpp v140, v140, v140 row_ror:1 row_mask:0xf bank_mask:0xf
  v_add_f32_dpp v141, v141, v141 row_ror:1 row_mask:0xf bank_mask:0xf
  v_add_f32_dpp v142, v142, v142 row_ror:1 row_mask:0xf bank_mask:0xf
  v_add_f32_dpp v143, v143, v143 row_ror:1 row_mask:0xf bank_mask:0xf
  v_pk_fma_f32 v[36:37], v[140:141], s[62:63], v[36:37]
  v_pk_fma_f32 v[38:39], v[142:143], s[62:63], v[38:39]
  v_cvt_pk_bf16_f32 v33, v34, v35
  v_cvt_pk_bf16_f32 v34, v36, v37
  v_cvt_pk_bf16_f32 v35, v38, v39
  v_pk_fma_f32 v[60:61], v[140:141], s[62:63], v[60:61]
  ds_write_b128 v88, v[32:35] offset:1024
  v_pk_fma_f32 v[62:63], v[142:143], s[62:63], v[62:63]
  v_cvt_pk_bf16_f32 v56, v56, v57
  v_cvt_pk_bf16_f32 v57, v58, v59
  v_cvt_pk_bf16_f32 v58, v60, v61
  v_cvt_pk_bf16_f32 v59, v62, v63
  v_pk_fma_f32 v[252:253], v[140:141], s[62:63], v[252:253]
  ds_write_b128 v88, v[56:59] offset:4096
  v_pk_fma_f32 v[254:255], v[142:143], s[62:63], v[254:255]
  v_cvt_pk_bf16_f32 v248, v248, v249
  v_cvt_pk_bf16_f32 v249, v250, v251
  v_cvt_pk_bf16_f32 v250, v252, v253
  v_cvt_pk_bf16_f32 v251, v254, v255
  v_pk_fma_f32 v[188:189], v[140:141], s[62:63], v[188:189]
  ds_write_b128 v88, v[248:251] offset:7168
  v_pk_fma_f32 v[190:191], v[142:143], s[62:63], v[190:191]
  v_cvt_pk_bf16_f32 v184, v184, v185
  v_cvt_pk_bf16_f32 v185, v186, v187
  v_cvt_pk_bf16_f32 v186, v188, v189
  v_cvt_pk_bf16_f32 v187, v190, v191
  v_pk_fma_f32 v[108:109], v[140:141], s[62:63], v[108:109]
  ds_write_b128 v88, v[184:187] offset:10240
  v_pk_fma_f32 v[110:111], v[142:143], s[62:63], v[110:111]
  v_cvt_pk_bf16_f32 v96, v96, v97
  v_cvt_pk_bf16_f32 v97, v98, v99
  v_cvt_pk_bf16_f32 v98, v108, v109
  v_cvt_pk_bf16_f32 v99, v110, v111
  v_pk_fma_f32 v[112:113], v[140:141], s[62:63], v[112:113]
  ds_write_b128 v88, v[96:99] offset:13312
  v_pk_fma_f32 v[114:115], v[142:143], s[62:63], v[114:115]
  v_cvt_pk_bf16_f32 v100, v100, v101
  v_cvt_pk_bf16_f32 v101, v102, v103
  v_cvt_pk_bf16_f32 v102, v112, v113
  v_cvt_pk_bf16_f32 v103, v114, v115
  v_pk_add_f32 v[152:153], v[152:153], v[120:121]
  ds_write_b128 v89, v[100:103] offset:2048
  v_pk_add_f32 v[152:153], v[152:153], v[124:125]
  v_pk_add_f32 v[154:155], v[154:155], v[122:123]
  v_pk_add_f32 v[164:165], v[164:165], v[132:133]
  v_pk_add_f32 v[154:155], v[154:155], v[126:127]
  v_add_f32_dpp v152, v152, v152 row_ror:8 row_mask:0xf bank_mask:0xf
  v_add_f32_dpp v153, v153, v153 row_ror:8 row_mask:0xf bank_mask:0xf
  v_add_f32_dpp v154, v154, v154 row_ror:8 row_mask:0xf bank_mask:0xf
  v_add_f32_dpp v155, v155, v155 row_ror:8 row_mask:0xf bank_mask:0xf
  v_add_f32_dpp v152, v152, v152 row_ror:4 row_mask:0xf bank_mask:0xf
  v_add_f32_dpp v153, v153, v153 row_ror:4 row_mask:0xf bank_mask:0xf
  v_add_f32_dpp v154, v154, v154 row_ror:4 row_mask:0xf bank_mask:0xf
  v_add_f32_dpp v155, v155, v155 row_ror:4 row_mask:0xf bank_mask:0xf
  v_add_f32_dpp v152, v152, v152 row_ror:2 row_mask:0xf bank_mask:0xf
  v_add_f32_dpp v153, v153, v153 row_ror:2 row_mask:0xf bank_mask:0xf
  v_add_f32_dpp v154, v154, v154 row_ror:2 row_mask:0xf bank_mask:0xf
  v_add_f32_dpp v155, v155, v155 row_ror:2 row_mask:0xf bank_mask:0xf
  v_add_f32_dpp v152, v152, v152 row_ror:1 row_mask:0xf bank_mask:0xf
  v_add_f32_dpp v153, v153, v153 row_ror:1 row_mask:0xf bank_mask:0xf
  v_add_f32_dpp v154, v154, v154 row_ror:1 row_mask:0xf bank_mask:0xf
  v_add_f32_dpp v155, v155, v155 row_ror:1 row_mask:0xf bank_mask:0xf
  v_pk_fma_f32 v[40:41], v[152:153], s[62:63], v[40:41]
  v_pk_fma_f32 v[42:43], v[154:155], s[62:63], v[42:43]
  v_pk_fma_f32 v[64:65], v[152:153], s[62:63], v[64:65]
  v_pk_fma_f32 v[66:67], v[154:155], s[62:63], v[66:67]
  v_pk_fma_f32 v[168:169], v[152:153], s[62:63], v[168:169]
  v_pk_fma_f32 v[170:171], v[154:155], s[62:63], v[170:171]
  v_pk_fma_f32 v[192:193], v[152:153], s[62:63], v[192:193]
  v_pk_fma_f32 v[194:195], v[154:155], s[62:63], v[194:195]
  v_pk_fma_f32 v[120:121], v[152:153], s[62:63], v[120:121]
  v_pk_fma_f32 v[122:123], v[154:155], s[62:63], v[122:123]
  v_pk_fma_f32 v[124:125], v[152:153], s[62:63], v[124:125]
  v_pk_fma_f32 v[126:127], v[154:155], s[62:63], v[126:127]
  v_pk_add_f32 v[164:165], v[164:165], v[136:137]
  v_pk_add_f32 v[166:167], v[166:167], v[134:135]
  v_cvt_pk_bf16_f32 v40, v40, v41
  v_pk_add_f32 v[166:167], v[166:167], v[138:139]
  v_add_f32_dpp v164, v164, v164 row_ror:8 row_mask:0xf bank_mask:0xf
  v_add_f32_dpp v165, v165, v165 row_ror:8 row_mask:0xf bank_mask:0xf
  v_add_f32_dpp v166, v166, v166 row_ror:8 row_mask:0xf bank_mask:0xf
  v_add_f32_dpp v167, v167, v167 row_ror:8 row_mask:0xf bank_mask:0xf
  v_add_f32_dpp v164, v164, v164 row_ror:4 row_mask:0xf bank_mask:0xf
  v_add_f32_dpp v165, v165, v165 row_ror:4 row_mask:0xf bank_mask:0xf
  v_add_f32_dpp v166, v166, v166 row_ror:4 row_mask:0xf bank_mask:0xf
  v_add_f32_dpp v167, v167, v167 row_ror:4 row_mask:0xf bank_mask:0xf
  v_add_f32_dpp v164, v164, v164 row_ror:2 row_mask:0xf bank_mask:0xf
  v_add_f32_dpp v165, v165, v165 row_ror:2 row_mask:0xf bank_mask:0xf
  v_add_f32_dpp v166, v166, v166 row_ror:2 row_mask:0xf bank_mask:0xf
  v_add_f32_dpp v167, v167, v167 row_ror:2 row_mask:0xf bank_mask:0xf
  v_add_f32_dpp v164, v164, v164 row_ror:1 row_mask:0xf bank_mask:0xf
  v_add_f32_dpp v165, v165, v165 row_ror:1 row_mask:0xf bank_mask:0xf
  v_add_f32_dpp v166, v166, v166 row_ror:1 row_mask:0xf bank_mask:0xf
  v_add_f32_dpp v167, v167, v167 row_ror:1 row_mask:0xf bank_mask:0xf
  v_pk_fma_f32 v[44:45], v[164:165], s[62:63], v[44:45]
  v_pk_fma_f32 v[46:47], v[166:167], s[62:63], v[46:47]
  v_cvt_pk_bf16_f32 v41, v42, v43
  v_cvt_pk_bf16_f32 v42, v44, v45
  v_cvt_pk_bf16_f32 v43, v46, v47
  v_pk_fma_f32 v[68:69], v[164:165], s[62:63], v[68:69]
  ds_write_b128 v88, v[40:43] offset:2048
  v_pk_fma_f32 v[70:71], v[166:167], s[62:63], v[70:71]
  v_cvt_pk_bf16_f32 v64, v64, v65
  v_cvt_pk_bf16_f32 v65, v66, v67
  v_cvt_pk_bf16_f32 v66, v68, v69
  v_cvt_pk_bf16_f32 v67, v70, v71
  v_pk_fma_f32 v[172:173], v[164:165], s[62:63], v[172:173]
  ds_write_b128 v88, v[64:67] offset:5120
  v_pk_fma_f32 v[174:175], v[166:167], s[62:63], v[174:175]
  v_cvt_pk_bf16_f32 v168, v168, v169
  v_cvt_pk_bf16_f32 v169, v170, v171
  v_cvt_pk_bf16_f32 v170, v172, v173
  v_cvt_pk_bf16_f32 v171, v174, v175
  v_pk_fma_f32 v[196:197], v[164:165], s[62:63], v[196:197]
  ds_write_b128 v88, v[168:171] offset:8192
  v_pk_fma_f32 v[198:199], v[166:167], s[62:63], v[198:199]
  v_cvt_pk_bf16_f32 v192, v192, v193
  v_cvt_pk_bf16_f32 v193, v194, v195
  v_cvt_pk_bf16_f32 v194, v196, v197
  v_cvt_pk_bf16_f32 v195, v198, v199
  v_pk_fma_f32 v[132:133], v[164:165], s[62:63], v[132:133]
  s_waitcnt lgkmcnt(14)
  ds_write_b128 v88, v[192:195] offset:11264
  v_pk_fma_f32 v[134:135], v[166:167], s[62:63], v[134:135]
  v_cvt_pk_bf16_f32 v120, v120, v121
  v_cvt_pk_bf16_f32 v121, v122, v123
  v_cvt_pk_bf16_f32 v122, v132, v133
  v_cvt_pk_bf16_f32 v123, v134, v135
  v_pk_fma_f32 v[136:137], v[164:165], s[62:63], v[136:137]
  s_waitcnt lgkmcnt(14)
  ds_write_b128 v89, v[120:123] offset:0
  v_pk_fma_f32 v[138:139], v[166:167], s[62:63], v[138:139]
  v_cvt_pk_bf16_f32 v124, v124, v125
  v_cvt_pk_bf16_f32 v125, v126, v127
  v_cvt_pk_bf16_f32 v126, v136, v137
  v_cvt_pk_bf16_f32 v127, v138, v139
  s_waitcnt lgkmcnt(14)
  ds_write_b128 v89, v[124:127] offset:3072
  s_branch main_f1
main_fV:
  s_add_u32 m0, s45, 0
  s_add_u32 s24, s22, 0
  s_mov_b32 exec_hi, 0xffff
  buffer_load_dwordx4 v3, s[4:7], s24 offen nt lds
  s_mov_b32 exec_hi, -1
  v_mfma_f32_16x16x32_bf16 v[24:27], v[168:171], v[20:23], 0
  v_mfma_f32_16x16x32_bf16 v[28:31], v[180:183], v[20:23], 0
  v_mfma_f32_16x16x32_bf16 v[32:35], v[192:195], v[20:23], 0
  v_mfma_f32_16x16x32_bf16 v[36:39], v[204:207], v[20:23], 0
  v_mfma_f32_16x16x32_bf16 v[40:43], v[216:219], v[20:23], 0
  v_mfma_f32_16x16x32_bf16 v[44:47], v[228:231], v[20:23], 0
  s_nop 2
  v_cvt_pk_bf16_f32 v24, v24, v25
  v_cvt_pk_bf16_f32 v25, v26, v27
  v_cvt_pk_bf16_f32 v26, v28, v29
  v_cvt_pk_bf16_f32 v27, v30, v31
  v_mfma_f32_16x16x32_bf16 v[28:31], v[180:183], v[18:21], 0
  v_cvt_pk_bf16_f32 v32, v32, v33
  v_cvt_pk_bf16_f32 v33, v34, v35
  v_mfma_f32_16x16x32_bf16 v[48:51], v[96:99], v[24:27], 0
  s_add_u32 m0, s45, 784
  s_add_u32 s24, s22, 50135232
  s_mov_b32 exec_hi, 0xffff
  buffer_load_dwordx4 v3, s[4:7], s24 offen nt lds
  s_mov_b32 exec_hi, -1
  v_cvt_pk_bf16_f32 v34, v36, v37
  v_mfma_f32_16x16x32_bf16 v[52:55], v[108:111], v[24:27], 0
  v_cvt_pk_bf16_f32 v35, v38, v39
  v_cvt_pk_bf16_f32 v40, v40, v41
  v_mfma_f32_16x16x32_bf16 v[56:59], v[120:123], v[24:27], 0
  v_cvt_pk_bf16_f32 v41, v42, v43
  v_cvt_pk_bf16_f32 v42, v44, v45
  v_mfma_f32_16x16x32_bf16 v[60:63], v[132:135], v[24:27], 0
  v_cvt_pk_bf16_f32 v43, v46, v47
  v_mfma_f32_16x16x32_bf16 v[64:67], v[144:147], v[24:27], 0
  v_mfma_f32_16x16x32_bf16 v[68:71], v[156:159], v[24:27], 0
  v_mfma_f32_16x16x32_bf16 v[48:51], v[100:103], v[32:35], v[48:51]
  v_mfma_f32_16x16x32_bf16 v[52:55], v[112:115], v[32:35], v[52:55]
  v_mfma_f32_16x16x32_bf16 v[56:59], v[124:127], v[32:35], v[56:59]
  v_mfma_f32_16x16x32_bf16 v[60:63], v[136:139], v[32:35], v[60:63]
  s_add_u32 m0, s45, 1568
  s_add_u32 s24, s22, 100270464
  s_mov_b32 exec_hi, 0xffff
  buffer_load_dwordx4 v3, s[4:7], s24 offen nt lds
  s_mov_b32 exec_hi, -1
  v_mfma_f32_16x16x32_bf16 v[64:67], v[148:151], v[32:35], v[64:67]
  v_mfma_f32_16x16x32_bf16 v[68:71], v[160:163], v[32:35], v[68:71]
  v_mfma_f32_16x16x32_bf16 v[48:51], v[104:107], v[40:43], v[48:51]
  v_mfma_f32_16x16x32_bf16 v[52:55], v[116:119], v[40:43], v[52:55]
  v_mfma_f32_16x16x32_bf16 v[56:59], v[128:131], v[40:43], v[56:59]
  v_mfma_f32_16x16x32_bf16 v[60:63], v[140:143], v[40:43], v[60:63]
  v_mfma_f32_16x16x32_bf16 v[64:67], v[152:155], v[40:43], v[64:67]
  v_mfma_f32_16x16x32_bf16 v[68:71], v[164:167], v[40:43], v[68:71]
  v_mfma_f32_16x16x32_bf16 v[24:27], v[168:171], v[18:21], 0
  s_add_u32 m0, s45, 2352
  s_add_u32 s24, s22, 150405696
  s_mov_b32 exec_hi, 0xffff
  buffer_load_dwordx4 v3, s[4:7], s24 offen nt lds
  s_mov_b32 exec_hi, -1
  s_nop 0
  v_pk_add_f32 v[84:85], v[48:49], v[50:51]
  v_mfma_f32_16x16x32_bf16 v[32:35], v[192:195], v[18:21], 0
  v_pk_add_f32 v[84:85], v[84:85], v[52:53]
  v_pk_add_f32 v[84:85], v[84:85], v[54:55]
  v_mfma_f32_16x16x32_bf16 v[36:39], v[204:207], v[18:21], 0
  v_pk_add_f32 v[84:85], v[84:85], v[56:57]
  v_cvt_pk_bf16_f32 v24, v24, v25
  v_mfma_f32_16x16x32_bf16 v[40:43], v[216:219], v[18:21], 0
  v_pk_add_f32 v[84:85], v[84:85], v[58:59]
  v_cvt_pk_bf16_f32 v25, v26, v27
  v_mfma_f32_16x16x32_bf16 v[44:47], v[228:231], v[18:21], 0
  v_pk_add_f32 v[84:85], v[84:85], v[60:61]
  v_cvt_pk_bf16_f32 v26, v28, v29
  v_pk_add_f32 v[84:85], v[84:85], v[62:63]
  v_cvt_pk_bf16_f32 v27, v30, v31
  v_mfma_f32_16x16x32_bf16 v[28:31], v[184:187], v[20:23], 0
  v_pk_add_f32 v[84:85], v[84:85], v[64:65]
  v_cvt_pk_bf16_f32 v32, v32, v33
  v_mfma_f32_16x16x32_bf16 v[240:243], v[96:99], v[24:27], 0
  v_pk_add_f32 v[84:85], v[84:85], v[66:67]
  v_cvt_pk_bf16_f32 v33, v34, v35
  v_mfma_f32_16x16x32_bf16 v[244:247], v[108:111], v[24:27], 0
  v_pk_add_f32 v[84:85], v[84:85], v[68:69]
  v_cvt_pk_bf16_f32 v34, v36, v37
  v_mfma_f32_16x16x32_bf16 v[248:251], v[120:123], v[24:27], 0
  s_add_u32 m0, s45, 3152
  s_add_u32 s24, s22, 0
  s_mov_b32 exec_hi, 0xffff
  buffer_load_dwordx4 v4, s[4:7], s24 offen nt lds
  s_mov_b32 exec_hi, -1
  v_pk_add_f32 v[84:85], v[84:85], v[70:71]
  v_mfma_f32_16x16x32_bf16 v[252:255], v[132:135], v[24:27], 0
  v_add_f32 v84, v84, v85
  v_cvt_pk_bf16_f32 v35, v38, v39
  v_mfma_f32_16x16x32_bf16 v[36:39], v[208:211], v[20:23], 0
  v_mov_b32 v85, v84
  v_cvt_pk_bf16_f32 v40, v40, v41
  v_mfma_f32_16x16x32_bf16 v[240:243], v[100:103], v[32:35], v[240:243]
  v_permlane32_swap_b32 v84, v85
  v_mfma_f32_16x16x32_bf16 v[244:247], v[112:115], v[32:35], v[244:247]
  v_add_f32 v84, v84, v85
  v_cvt_pk_bf16_f32 v41, v42, v43
  v_mfma_f32_16x16x32_bf16 v[248:251], v[124:127], v[32:35], v[248:251]
  v_mov_b32 v85, v84
  v_cvt_pk_bf16_f32 v42, v44, v45
  v_mfma_f32_16x16x32_bf16 v[252:255], v[136:139], v[32:35], v[252:255]
  v_permlane16_swap_b32 v84, v85
  v_cvt_pk_bf16_f32 v43, v46, v47
  v_mfma_f32_16x16x32_bf16 v[44:47], v[232:235], v[20:23], 0
  v_add_f32 v84, v84, v85
  v_mul_f32 v85, s26, v84
  v_mfma_f32_16x16x32_bf16 v[240:243], v[104:107], v[40:43], v[240:243]
  v_mul_f32 v84, s26, v84
  s_add_u32 m0, s45, 3936
  s_add_u32 s24, s22, 50135232
  s_mov_b32 exec_hi, 0xffff
  buffer_load_dwordx4 v4, s[4:7], s24 offen nt lds
  s_mov_b32 exec_hi, -1
  v_mfma_f32_16x16x32_bf16 v[244:247], v[116:119], v[40:43], v[244:247]
  v_pk_fma_f32 v[48:49], v[48:49], s[28:29], v[84:85]
  v_pk_fma_f32 v[50:51], v[50:51], s[28:29], v[84:85]
  v_mfma_f32_16x16x32_bf16 v[248:251], v[128:131], v[40:43], v[248:251]
  v_pk_fma_f32 v[52:53], v[52:53], s[28:29], v[84:85]
  v_pk_fma_f32 v[54:55], v[54:55], s[28:29], v[84:85]
  v_mfma_f32_16x16x32_bf16 v[252:255], v[140:143], v[40:43], v[252:255]
  v_pk_fma_f32 v[56:57], v[56:57], s[28:29], v[84:85]
  v_pk_fma_f32 v[58:59], v[58:59], s[28:29], v[84:85]
  v_pk_fma_f32 v[60:61], v[60:61], s[28:29], v[84:85]
  v_pk_fma_f32 v[62:63], v[62:63], s[28:29], v[84:85]
  v_pk_fma_f32 v[64:65], v[64:65], s[28:29], v[84:85]
  v_pk_fma_f32 v[66:67], v[66:67], s[28:29], v[84:85]
  v_pk_fma_f32 v[68:69], v[68:69], s[28:29], v[84:85]
  v_pk_fma_f32 v[70:71], v[70:71], s[28:29], v[84:85]
  v_cvt_pk_bf16_f32 v48, v48, v49
  v_cvt_pk_bf16_f32 v49, v50, v51
  v_cvt_pk_bf16_f32 v50, v52, v53
  v_cvt_pk_bf16_f32 v51, v54, v55
  v_mfma_f32_16x16x32_bf16 v[52:55], v[156:159], v[24:27], 0
  ds_write_b128 v88, v[48:51] offset:0
  v_cvt_pk_bf16_f32 v56, v56, v57
  v_mfma_f32_16x16x32_bf16 v[52:55], v[160:163], v[32:35], v[52:55]
  v_cvt_pk_bf16_f32 v57, v58, v59
  v_cvt_pk_bf16_f32 v58, v60, v61
  v_mfma_f32_16x16x32_bf16 v[48:51], v[144:147], v[24:27], 0
  v_cvt_pk_bf16_f32 v59, v62, v63
  v_cvt_pk_bf16_f32 v64, v64, v65
  s_add_u32 m0, s45, 4720
  s_add_u32 s24, s22, 100270464
  s_mov_b32 exec_hi, 0xffff
  buffer_load_dwordx4 v4, s[4:7], s24 offen nt lds
  s_mov_b32 exec_hi, -1
  v_mfma_f32_16x16x32_bf16 v[48:51], v[148:151], v[32:35], v[48:51]
  ds_write_b128 v88, v[56:59] offset:1024
  v_cvt_pk_bf16_f32 v65, v66, v67
  v_mfma_f32_16x16x32_bf16 v[48:51], v[152:155], v[40:43], v[48:51]
  v_cvt_pk_bf16_f32 v66, v68, v69
  v_cvt_pk_bf16_f32 v67, v70, v71
  v_mfma_f32_16x16x32_bf16 v[52:55], v[164:167], v[40:43], v[52:55]
  ds_write_b128 v88, v[64:67] offset:2048
  v_pk_add_f32 v[86:87], v[240:241], v[242:243]
  v_mfma_f32_16x16x32_bf16 v[24:27], v[172:175], v[20:23], 0
  v_pk_add_f32 v[86:87], v[86:87], v[244:245]
  v_pk_add_f32 v[86:87], v[86:87], v[246:247]
  v_mfma_f32_16x16x32_bf16 v[32:35], v[196:199], v[20:23], 0
  v_pk_add_f32 v[86:87], v[86:87], v[248:249]
  v_pk_add_f32 v[86:87], v[86:87], v[250:251]
  v_mfma_f32_16x16x32_bf16 v[40:43], v[220:223], v[20:23], 0
  v_pk_add_f32 v[86:87], v[86:87], v[252:253]
  v_pk_add_f32 v[86:87], v[86:87], v[254:255]
  v_cvt_pk_bf16_f32 v24, v24, v25
  v_pk_add_f32 v[86:87], v[86:87], v[48:49]
  v_cvt_pk_bf16_f32 v25, v26, v27
  v_pk_add_f32 v[86:87], v[86:87], v[50:51]
  v_cvt_pk_bf16_f32 v26, v28, v29
  v_pk_add_f32 v[86:87], v[86:87], v[52:53]
  v_cvt_pk_bf16_f32 v27, v30, v31
  s_add_u32 m0, s45, 5504
  s_add_u32 s24, s22, 150405696
  s_mov_b32 exec_hi, 0xffff
  buffer_load_dwordx4 v4, s[4:7], s24 offen nt lds
  s_mov_b32 exec_hi, -1
  v_mfma_f32_16x16x32_bf16 v[28:31], v[184:187], v[18:21], 0
  v_pk_add_f32 v[86:87], v[86:87], v[54:55]
  v_cvt_pk_bf16_f32 v32, v32, v33
  v_mfma_f32_16x16x32_bf16 v[56:59], v[96:99], v[24:27], 0
  v_add_f32 v86, v86, v87
  v_cvt_pk_bf16_f32 v33, v34, v35
  v_mfma_f32_16x16x32_bf16 v[60:63], v[108:111], v[24:27], 0
  v_mov_b32 v87, v86
  v_cvt_pk_bf16_f32 v34, v36, v37
  v_mfma_f32_16x16x32_bf16 v[64:67], v[120:123], v[24:27], 0
  v_permlane32_swap_b32 v86, v87
  v_mfma_f32_16x16x32_bf16 v[68:71], v[132:135], v[24:27], 0
  v_add_f32 v86, v86, v87
  v_cvt_pk_bf16_f32 v35, v38, v39
  v_mfma_f32_16x16x32_bf16 v[36:39], v[208:211], v[18:21], 0
  v_mov_b32 v87, v86
  v_cvt_pk_bf16_f32 v40, v40, v41
  v_mfma_f32_16x16x32_bf16 v[56:59], v[100:103], v[32:35], v[56:59]
  v_permlane16_swap_b32 v86, v87
  v_mfma_f32_16x16x32_bf16 v[60:63], v[112:115], v[32:35], v[60:63]
  v_add_f32 v86, v86, v87
  v_cvt_pk_bf16_f32 v41, v42, v43
  v_mfma_f32_16x16x32_bf16 v[64:67], v[124:127], v[32:35], v[64:67]
  s_add_u32 m0, s45, 6304
  s_add_u32 s24, s22, 0
  s_mov_b32 exec_hi, 0xffff
  buffer_load_dwordx4 v5, s[4:7], s24 offen nt lds
  s_mov_b32 exec_hi, -1
  v_mul_f32 v87, s26, v86
  v_mfma_f32_16x16x32_bf16 v[68:71], v[136:139], v[32:35], v[68:71]
  v_mul_f32 v86, s26, v86
  v_cvt_pk_bf16_f32 v42, v44, v45
  v_pk_fma_f32 v[240:241], v[240:241], s[28:29], v[86:87]
  v_pk_fma_f32 v[242:243], v[242:243], s[28:29], v[86:87]
  v_pk_fma_f32 v[244:245], v[244:245], s[28:29], v[86:87]
  v_pk_fma_f32 v[246:247], v[246:247], s[28:29], v[86:87]
  v_pk_fma_f32 v[248:249], v[248:249], s[28:29], v[86:87]
  v_pk_fma_f32 v[250:251], v[250:251], s[28:29], v[86:87]
  v_pk_fma_f32 v[252:253], v[252:253], s[28:29], v[86:87]
  v_pk_fma_f32 v[254:255], v[254:255], s[28:29], v[86:87]
  v_pk_fma_f32 v[48:49], v[48:49], s[28:29], v[86:87]
  v_pk_fma_f32 v[50:51], v[50:51], s[28:29], v[86:87]
  v_pk_fma_f32 v[52:53], v[52:53], s[28:29], v[86:87]
  v_pk_fma_f32 v[54:55], v[54:55], s[28:29], v[86:87]
  v_cvt_pk_bf16_f32 v240, v240, v241
  v_cvt_pk_bf16_f32 v241, v242, v243
  v_cvt_pk_bf16_f32 v242, v244, v245
  v_cvt_pk_bf16_f32 v243, v246, v247
  v_mfma_f32_16x16x32_bf16 v[244:247], v[156:159], v[24:27], 0
  ds_write_b128 v88, v[240:243] offset:3072
  v_cvt_pk_bf16_f32 v248, v248, v249
  v_mfma_f32_16x16x32_bf16 v[244:247], v[160:163], v[32:35], v[244:247]
  v_cvt_pk_bf16_f32 v249, v250, v251
  v_cvt_pk_bf16_f32 v250, v252, v253
  v_mfma_f32_16x16x32_bf16 v[240:243], v[144:147], v[24:27], 0
  v_cvt_pk_bf16_f32 v251, v254, v255
  v_cvt_pk_bf16_f32 v48, v48, v49
  v_mfma_f32_16x16x32_bf16 v[240:243], v[148:151], v[32:35], v[240:243]
  s_add_u32 m0, s45, 7088
  s_add_u32 s24, s22, 50135232
  s_mov_b32 exec_hi, 0xffff
  buffer_load_dwordx4 v5, s[4:7], s24 offen nt lds
  s_mov_b32 exec_hi, -1
  ds_write_b128 v88, v[248:251] offset:4096
  v_mfma_f32_16x16x32_bf16 v[24:27], v[172:175], v[18:21], 0
  v_cvt_pk_bf16_f32 v49, v50, v51
  v_cvt_pk_bf16_f32 v50, v52, v53
  v_mfma_f32_16x16x32_bf16 v[32:35], v[196:199], v[18:21], 0
  v_cvt_pk_bf16_f32 v51, v54, v55
  v_cvt_pk_bf16_f32 v43, v46, v47
  v_mfma_f32_16x16x32_bf16 v[44:47], v[232:235], v[18:21], 0
  ds_write_b128 v88, v[48:51] offset:5120
  v_mfma_f32_16x16x32_bf16 v[56:59], v[104:107], v[40:43], v[56:59]
  v_cvt_pk_bf16_f32 v24, v24, v25
  v_cvt_pk_bf16_f32 v25, v26, v27
  v_mfma_f32_16x16x32_bf16 v[60:63], v[116:119], v[40:43], v[60:63]
  v_cvt_pk_bf16_f32 v26, v28, v29
  v_cvt_pk_bf16_f32 v27, v30, v31
  v_mfma_f32_16x16x32_bf16 v[64:67], v[128:131], v[40:43], v[64:67]
  v_cvt_pk_bf16_f32 v32, v32, v33
  v_cvt_pk_bf16_f32 v33, v34, v35
  v_mfma_f32_16x16x32_bf16 v[68:71], v[140:143], v[40:43], v[68:71]
  v_pk_add_f32 v[84:85], v[56:57], v[58:59]
  v_cvt_pk_bf16_f32 v34, v36, v37
  v_mfma_f32_16x16x32_bf16 v[240:243], v[152:155], v[40:43], v[240:243]
  v_pk_add_f32 v[84:85], v[84:85], v[60:61]
  v_cvt_pk_bf16_f32 v35, v38, v39
  v_mfma_f32_16x16x32_bf16 v[244:247], v[164:167], v[40:43], v[244:247]
  s_add_u32 m0, s45, 7872
  s_add_u32 s24, s22, 100270464
  s_mov_b32 exec_hi, 0xffff
  buffer_load_dwordx4 v5, s[4:7], s24 offen nt lds
  s_mov_b32 exec_hi, -1
  v_pk_add_f32 v[84:85], v[84:85], v[62:63]
  v_mfma_f32_16x16x32_bf16 v[40:43], v[220:223], v[18:21], 0
  v_pk_add_f32 v[84:85], v[84:85], v[64:65]
  v_pk_add_f32 v[84:85], v[84:85], v[66:67]
  v_mfma_f32_16x16x32_bf16 v[248:251], v[96:99], v[24:27], 0
  v_pk_add_f32 v[84:85], v[84:85], v[68:69]
  v_pk_add_f32 v[84:85], v[84:85], v[70:71]
  v_mfma_f32_16x16x32_bf16 v[252:255], v[108:111], v[24:27], 0
  v_pk_add_f32 v[84:85], v[84:85], v[240:241]
  v_pk_add_f32 v[84:85], v[84:85], v[242:243]
  v_mfma_f32_16x16x32_bf16 v[48:51], v[120:123], v[24:27], 0
  v_pk_add_f32 v[84:85], v[84:85], v[244:245]
  v_cvt_pk_bf16_f32 v40, v40, v41
  v_mfma_f32_16x16x32_bf16 v[52:55], v[132:135], v[24:27], 0
  v_pk_add_f32 v[84:85], v[84:85], v[246:247]
  v_cvt_pk_bf16_f32 v41, v42, v43
  v_mfma_f32_16x16x32_bf16 v[248:251], v[100:103], v[32:35], v[248:251]
  v_add_f32 v84, v84, v85
  v_cvt_pk_bf16_f32 v42, v44, v45
  v_mfma_f32_16x16x32_bf16 v[252:255], v[112:115], v[32:35], v[252:255]
  v_mov_b32 v85, v84
  v_cvt_pk_bf16_f32 v43, v46, v47
  v_mfma_f32_16x16x32_bf16 v[48:51], v[124:127], v[32:35], v[48:51]
  s_add_u32 m0, s45, 8656
  s_add_u32 s24, s22, 150405696
  s_mov_b32 exec_hi, 0xffff
  buffer_load_dwordx4 v5, s[4:7], s24 offen nt lds
  s_mov_b32 exec_hi, -1
  v_permlane32_swap_b32 v84, v85
  v_mfma_f32_16x16x32_bf16 v[52:55], v[136:139], v[32:35], v[52:55]
  v_add_f32 v84, v84, v85
  v_mov_b32 v85, v84
  v_mfma_f32_16x16x32_bf16 v[248:251], v[104:107], v[40:43], v[248:251]
  s_nop 0
  v_permlane16_swap_b32 v84, v85
  v_mfma_f32_16x16x32_bf16 v[252:255], v[116:119], v[40:43], v[252:255]
  v_add_f32 v84, v84, v85
  v_mul_f32 v85, s26, v84
  v_mfma_f32_16x16x32_bf16 v[48:51], v[128:131], v[40:43], v[48:51]
  v_mul_f32 v84, s26, v84
  v_pk_fma_f32 v[56:57], v[56:57], s[28:29], v[84:85]
  v_mfma_f32_16x16x32_bf16 v[52:55], v[140:143], v[40:43], v[52:55]
  v_pk_fma_f32 v[58:59], v[58:59], s[28:29], v[84:85]
  v_pk_fma_f32 v[60:61], v[60:61], s[28:29], v[84:85]
  v_pk_fma_f32 v[62:63], v[62:63], s[28:29], v[84:85]
  v_pk_fma_f32 v[64:65], v[64:65], s[28:29], v[84:85]
  v_pk_fma_f32 v[66:67], v[66:67], s[28:29], v[84:85]
  v_pk_fma_f32 v[68:69], v[68:69], s[28:29], v[84:85]
  v_pk_fma_f32 v[70:71], v[70:71], s[28:29], v[84:85]
  v_pk_fma_f32 v[240:241], v[240:241], s[28:29], v[84:85]
  v_pk_fma_f32 v[242:243], v[242:243], s[28:29], v[84:85]
  v_pk_fma_f32 v[244:245], v[244:245], s[28:29], v[84:85]
  v_pk_fma_f32 v[246:247], v[246:247], s[28:29], v[84:85]
  v_cvt_pk_bf16_f32 v56, v56, v57
  v_cvt_pk_bf16_f32 v57, v58, v59
  v_cvt_pk_bf16_f32 v58, v60, v61
  v_cvt_pk_bf16_f32 v59, v62, v63
  v_mfma_f32_16x16x32_bf16 v[60:63], v[156:159], v[24:27], 0
  ds_write_b128 v88, v[56:59] offset:6144
  v_cvt_pk_bf16_f32 v64, v64, v65
  v_mfma_f32_16x16x32_bf16 v[60:63], v[160:163], v[32:35], v[60:63]
  v_cvt_pk_bf16_f32 v65, v66, v67
  v_cvt_pk_bf16_f32 v66, v68, v69
  v_mfma_f32_16x16x32_bf16 v[56:59], v[144:147], v[24:27], 0
  v_cvt_pk_bf16_f32 v67, v70, v71
  v_cvt_pk_bf16_f32 v240, v240, v241
  v_mfma_f32_16x16x32_bf16 v[56:59], v[148:151], v[32:35], v[56:59]
  ds_write_b128 v88, v[64:67] offset:7168
  v_cvt_pk_bf16_f32 v241, v242, v243
  v_mfma_f32_16x16x32_bf16 v[56:59], v[152:155], v[40:43], v[56:59]
  v_cvt_pk_bf16_f32 v242, v244, v245
  v_cvt_pk_bf16_f32 v243, v246, v247
  v_mfma_f32_16x16x32_bf16 v[60:63], v[164:167], v[40:43], v[60:63]
  ds_write_b128 v88, v[240:243] offset:8192
  v_pk_add_f32 v[86:87], v[248:249], v[250:251]
  v_pk_add_f32 v[86:87], v[86:87], v[252:253]
  v_pk_add_f32 v[86:87], v[86:87], v[254:255]
  v_pk_add_f32 v[86:87], v[86:87], v[48:49]
  v_pk_add_f32 v[86:87], v[86:87], v[50:51]
  v_pk_add_f32 v[86:87], v[86:87], v[52:53]
  v_pk_add_f32 v[86:87], v[86:87], v[54:55]
  v_pk_add_f32 v[86:87], v[86:87], v[56:57]
  v_pk_add_f32 v[86:87], v[86:87], v[58:59]
  v_pk_add_f32 v[86:87], v[86:87], v[60:61]
  v_pk_add_f32 v[86:87], v[86:87], v[62:63]
  v_add_f32 v86, v86, v87
  v_mov_b32 v87, v86
  s_nop 1
  v_permlane32_swap_b32 v86, v87
  v_add_f32 v86, v86, v87
  v_mov_b32 v87, v86
  s_nop 1
  v_permlane16_swap_b32 v86, v87
  v_add_f32 v86, v86, v87
  v_mul_f32 v87, s26, v86
  v_mul_f32 v86, s26, v86
  v_pk_fma_f32 v[248:249], v[248:249], s[28:29], v[86:87]
  v_pk_fma_f32 v[250:251], v[250:251], s[28:29], v[86:87]
  v_pk_fma_f32 v[252:253], v[252:253], s[28:29], v[86:87]
  v_pk_fma_f32 v[254:255], v[254:255], s[28:29], v[86:87]
  v_pk_fma_f32 v[48:49], v[48:49], s[28:29], v[86:87]
  v_pk_fma_f32 v[50:51], v[50:51], s[28:29], v[86:87]
  v_pk_fma_f32 v[52:53], v[52:53], s[28:29], v[86:87]
  v_pk_fma_f32 v[54:55], v[54:55], s[28:29], v[86:87]
  v_pk_fma_f32 v[56:57], v[56:57], s[28:29], v[86:87]
  v_pk_fma_f32 v[58:59], v[58:59], s[28:29], v[86:87]
  v_pk_fma_f32 v[60:61], v[60:61], s[28:29], v[86:87]
  v_pk_fma_f32 v[62:63], v[62:63], s[28:29], v[86:87]
  v_cvt_pk_bf16_f32 v248, v248, v249
  v_cvt_pk_bf16_f32 v249, v250, v251
  v_cvt_pk_bf16_f32 v250, v252, v253
  v_cvt_pk_bf16_f32 v251, v254, v255
  v_cvt_pk_bf16_f32 v48, v48, v49
  ds_write_b128 v88, v[248:251] offset:9216
  v_cvt_pk_bf16_f32 v49, v50, v51
  v_cvt_pk_bf16_f32 v50, v52, v53
  v_cvt_pk_bf16_f32 v51, v54, v55
  v_cvt_pk_bf16_f32 v56, v56, v57
  ds_write_b128 v88, v[48:51] offset:10240
  v_cvt_pk_bf16_f32 v57, v58, v59
  v_cvt_pk_bf16_f32 v58, v60, v61
  v_cvt_pk_bf16_f32 v59, v62, v63
  ds_write_b128 v88, v[56:59] offset:11264
  s_branch main_f1
main_fW:
  s_add_u32 m0, s45, 0
  s_add_u32 s24, s22, 0
  s_mov_b32 exec_hi, 0xffff
  buffer_load_dwordx4 v3, s[4:7], s24 offen nt lds
  s_mov_b32 exec_hi, -1
  v_mfma_f32_16x16x32_bf16 v[24:27], v[176:179], v[20:23], 0
  v_mfma_f32_16x16x32_bf16 v[28:31], v[188:191], v[20:23], 0
  v_mfma_f32_16x16x32_bf16 v[32:35], v[200:203], v[20:23], 0
  v_mfma_f32_16x16x32_bf16 v[36:39], v[212:215], v[20:23], 0
  s_add_u32 m0, s45, 784
  s_add_u32 s24, s22, 50135232
  s_mov_b32 exec_hi, 0xffff
  buffer_load_dwordx4 v3, s[4:7], s24 offen nt lds
  s_mov_b32 exec_hi, -1
  v_mfma_f32_16x16x32_bf16 v[40:43], v[224:227], v[20:23], 0
  v_mfma_f32_16x16x32_bf16 v[44:47], v[236:239], v[20:23], 0
  s_nop 1
  v_cvt_pk_bf16_f32 v24, v24, v25
  v_cvt_pk_bf16_f32 v25, v26, v27
  v_cvt_pk_bf16_f32 v26, v28, v29
  v_cvt_pk_bf16_f32 v27, v30, v31
  v_mfma_f32_16x16x32_bf16 v[28:31], v[188:191], v[18:21], 0
  s_add_u32 m0, s45, 1568
  s_add_u32 s24, s22, 100270464
  s_mov_b32 exec_hi, 0xffff
  buffer_load_dwordx4 v3, s[4:7], s24 offen nt lds
  s_mov_b32 exec_hi, -1
  v_cvt_pk_bf16_f32 v32, v32, v33
  v_mfma_f32_16x16x32_bf16 v[64:67], v[96:99], v[24:27], 0
  v_cvt_pk_bf16_f32 v33, v34, v35
  v_cvt_pk_bf16_f32 v34, v36, v37
  v_mfma_f32_16x16x32_bf16 v[68:71], v[108:111], v[24:27], 0
  v_cvt_pk_bf16_f32 v35, v38, v39
  v_cvt_pk_bf16_f32 v40, v40, v41
  v_mfma_f32_16x16x32_bf16 v[240:243], v[120:123], v[24:27], 0
  v_cvt_pk_bf16_f32 v41, v42, v43
  v_cvt_pk_bf16_f32 v42, v44, v45
  v_mfma_f32_16x16x32_bf16 v[244:247], v[132:135], v[24:27], 0
  s_add_u32 m0, s45, 2352
  s_add_u32 s24, s22, 150405696
  s_mov_b32 exec_hi, 0xffff
  buffer_load_dwordx4 v3, s[4:7], s24 offen nt lds
  s_mov_b32 exec_hi, -1
  v_cvt_pk_bf16_f32 v43, v46, v47
  v_mfma_f32_16x16x32_bf16 v[248:251], v[144:147], v[24:27], 0
  v_mfma_f32_16x16x32_bf16 v[252:255], v[156:159], v[24:27], 0
  v_mfma_f32_16x16x32_bf16 v[64:67], v[100:103], v[32:35], v[64:67]
  v_mfma_f32_16x16x32_bf16 v[68:71], v[112:115], v[32:35], v[68:71]
  s_add_u32 m0, s45, 3152
  s_add_u32 s24, s22, 0
  s_mov_b32 exec_hi, 0xffff
  buffer_load_dwordx4 v4, s[4:7], s24 offen nt lds
  s_mov_b32 exec_hi, -1
  v_mfma_f32_16x16x32_bf16 v[240:243], v[124:127], v[32:35], v[240:243]
  v_mfma_f32_16x16x32_bf16 v[244:247], v[136:139], v[32:35], v[244:247]
  v_mfma_f32_16x16x32_bf16 v[248:251], v[148:151], v[32:35], v[248:251]
  v_mfma_f32_16x16x32_bf16 v[252:255], v[160:163], v[32:35], v[252:255]
  s_add_u32 m0, s45, 3936
  s_add_u32 s24, s22, 50135232
  s_mov_b32 exec_hi, 0xffff
  buffer_load_dwordx4 v4, s[4:7], s24 offen nt lds
  s_mov_b32 exec_hi, -1
  v_mfma_f32_16x16x32_bf16 v[64:67], v[104:107], v[40:43], v[64:67]
  v_mfma_f32_16x16x32_bf16 v[68:71], v[116:119], v[40:43], v[68:71]
  v_mfma_f32_16x16x32_bf16 v[240:243], v[128:131], v[40:43], v[240:243]
  v_mfma_f32_16x16x32_bf16 v[244:247], v[140:143], v[40:43], v[244:247]
  s_add_u32 m0, s45, 4720
  s_add_u32 s24, s22, 100270464
  s_mov_b32 exec_hi, 0xffff
  buffer_load_dwordx4 v4, s[4:7], s24 offen nt lds
  s_mov_b32 exec_hi, -1
  v_mfma_f32_16x16x32_bf16 v[248:251], v[152:155], v[40:43], v[248:251]
  v_mfma_f32_16x16x32_bf16 v[252:255], v[164:167], v[40:43], v[252:255]
  s_nop 1
  v_pk_add_f32 v[84:85], v[64:65], v[66:67]
  v_mfma_f32_16x16x32_bf16 v[24:27], v[176:179], v[18:21], 0
  v_pk_add_f32 v[84:85], v[84:85], v[68:69]
  s_add_u32 m0, s45, 5504
  s_add_u32 s24, s22, 150405696
  s_mov_b32 exec_hi, 0xffff
  buffer_load_dwordx4 v4, s[4:7], s24 offen nt lds
  s_mov_b32 exec_hi, -1
  v_mfma_f32_16x16x32_bf16 v[32:35], v[200:203], v[18:21], 0
  v_pk_add_f32 v[84:85], v[84:85], v[70:71]
  v_pk_add_f32 v[84:85], v[84:85], v[240:241]
  v_mfma_f32_16x16x32_bf16 v[36:39], v[212:215], v[18:21], 0
  v_pk_add_f32 v[84:85], v[84:85], v[242:243]
  v_pk_add_f32 v[84:85], v[84:85], v[244:245]
  v_mfma_f32_16x16x32_bf16 v[40:43], v[224:227], v[18:21], 0
  v_pk_add_f32 v[84:85], v[84:85], v[246:247]
  v_cvt_pk_bf16_f32 v24, v24, v25
  s_add_u32 m0, s45, 6304
  s_add_u32 s24, s22, 0
  s_mov_b32 exec_hi, 0xffff
  buffer_load_dwordx4 v5, s[4:7], s24 offen nt lds
  s_mov_b32 exec_hi, -1
  v_mfma_f32_16x16x32_bf16 v[44:47], v[236:239], v[18:21], 0
  v_pk_add_f32 v[84:85], v[84:85], v[248:249]
  v_cvt_pk_bf16_f32 v25, v26, v27
  v_pk_add_f32 v[84:85], v[84:85], v[250:251]
  v_cvt_pk_bf16_f32 v26, v28, v29
  v_pk_add_f32 v[84:85], v[84:85], v[252:253]
  v_cvt_pk_bf16_f32 v27, v30, v31
  v_pk_add_f32 v[84:85], v[84:85], v[254:255]
  v_cvt_pk_bf16_f32 v32, v32, v33
  v_mfma_f32_16x16x32_bf16 v[48:51], v[96:99], v[24:27], 0
  v_add_f32 v84, v84, v85
  v_cvt_pk_bf16_f32 v33, v34, v35
  s_add_u32 m0, s45, 7088
  s_add_u32 s24, s22, 50135232
  s_mov_b32 exec_hi, 0xffff
  buffer_load_dwordx4 v5, s[4:7], s24 offen nt lds
  s_mov_b32 exec_hi, -1
  v_mfma_f32_16x16x32_bf16 v[52:55], v[108:111], v[24:27], 0
  v_mov_b32 v85, v84
  v_cvt_pk_bf16_f32 v34, v36, v37
  v_mfma_f32_16x16x32_bf16 v[56:59], v[120:123], v[24:27], 0
  v_permlane32_swap_b32 v84, v85
  v_mfma_f32_16x16x32_bf16 v[60:63], v[132:135], v[24:27], 0
  v_add_f32 v84, v84, v85
  v_cvt_pk_bf16_f32 v35, v38, v39
  v_mov_b32 v85, v84
  v_cvt_pk_bf16_f32 v40, v40, v41
  s_add_u32 m0, s45, 7872
  s_add_u32 s24, s22, 100270464
  s_mov_b32 exec_hi, 0xffff
  buffer_load_dwordx4 v5, s[4:7], s24 offen nt lds
  s_mov_b32 exec_hi, -1
  v_mfma_f32_16x16x32_bf16 v[48:51], v[100:103], v[32:35], v[48:51]
  v_permlane16_swap_b32 v84, v85
  v_mfma_f32_16x16x32_bf16 v[52:55], v[112:115], v[32:35], v[52:55]
  v_add_f32 v84, v84, v85
  v_cvt_pk_bf16_f32 v41, v42, v43
  v_mfma_f32_16x16x32_bf16 v[56:59], v[124:127], v[32:35], v[56:59]
  v_mul_f32 v85, s26, v84
  v_mul_f32 v84, s26, v84
  v_mfma_f32_16x16x32_bf16 v[60:63], v[136:139], v[32:35], v[60:63]
  s_add_u32 m0, s45, 8656
  s_add_u32 s24, s22, 150405696
  s_mov_b32 exec_hi, 0xffff
  buffer_load_dwordx4 v5, s[4:7], s24 offen nt lds
  s_mov_b32 exec_hi, -1
  v_pk_fma_f32 v[64:65], v[64:65], s[28:29], v[84:85]
  v_pk_fma_f32 v[66:67], v[66:67], s[28:29], v[84:85]
  v_pk_fma_f32 v[68:69], v[68:69], s[28:29], v[84:85]
  v_pk_fma_f32 v[70:71], v[70:71], s[28:29], v[84:85]
  v_pk_fma_f32 v[240:241], v[240:241], s[28:29], v[84:85]
  v_pk_fma_f32 v[242:243], v[242:243], s[28:29], v[84:85]
  v_pk_fma_f32 v[244:245], v[244:245], s[28:29], v[84:85]
  v_pk_fma_f32 v[246:247], v[246:247], s[28:29], v[84:85]
  v_pk_fma_f32 v[248:249], v[248:249], s[28:29], v[84:85]
  v_pk_fma_f32 v[250:251], v[250:251], s[28:29], v[84:85]
  v_pk_fma_f32 v[252:253], v[252:253], s[28:29], v[84:85]
  v_pk_fma_f32 v[254:255], v[254:255], s[28:29], v[84:85]
  v_cvt_pk_bf16_f32 v64, v64, v65
  v_cvt_pk_bf16_f32 v65, v66, v67
  v_cvt_pk_bf16_f32 v66, v68, v69
  v_cvt_pk_bf16_f32 v67, v70, v71
  v_mfma_f32_16x16x32_bf16 v[68:71], v[156:159], v[24:27], 0
  ds_write_b128 v88, v[64:67] offset:12288
  v_cvt_pk_bf16_f32 v240, v240, v241
  v_mfma_f32_16x16x32_bf16 v[68:71], v[160:163], v[32:35], v[68:71]
  v_cvt_pk_bf16_f32 v241, v242, v243
  v_cvt_pk_bf16_f32 v242, v244, v245
  v_mfma_f32_16x16x32_bf16 v[64:67], v[144:147], v[24:27], 0
  v_cvt_pk_bf16_f32 v243, v246, v247
  v_cvt_pk_bf16_f32 v248, v248, v249
  v_mfma_f32_16x16x32_bf16 v[64:67], v[148:151], v[32:35], v[64:67]
  ds_write_b128 v88, v[240:243] offset:13312
  v_cvt_pk_bf16_f32 v249, v250, v251
  v_cvt_pk_bf16_f32 v250, v252, v253
  v_cvt_pk_bf16_f32 v251, v254, v255
  v_cvt_pk_bf16_f32 v42, v44, v45
  ds_write_b128 v89, v[248:251] offset:0
  v_cvt_pk_bf16_f32 v43, v46, v47
  s_nop 1
  v_mfma_f32_16x16x32_bf16 v[48:51], v[104:107], v[40:43], v[48:51]
  v_mfma_f32_16x16x32_bf16 v[52:55], v[116:119], v[40:43], v[52:55]
  v_mfma_f32_16x16x32_bf16 v[56:59], v[128:131], v[40:43], v[56:59]
  v_mfma_f32_16x16x32_bf16 v[60:63], v[140:143], v[40:43], v[60:63]
  v_mfma_f32_16x16x32_bf16 v[64:67], v[152:155], v[40:43], v[64:67]
  v_mfma_f32_16x16x32_bf16 v[68:71], v[164:167], v[40:43], v[68:71]
  s_nop 2
  v_pk_add_f32 v[86:87], v[48:49], v[50:51]
  v_pk_add_f32 v[86:87], v[86:87], v[52:53]
  v_pk_add_f32 v[86:87], v[86:87], v[54:55]
  v_pk_add_f32 v[86:87], v[86:87], v[56:57]
  v_pk_add_f32 v[86:87], v[86:87], v[58:59]
  v_pk_add_f32 v[86:87], v[86:87], v[60:61]
  v_pk_add_f32 v[86:87], v[86:87], v[62:63]
  v_pk_add_f32 v[86:87], v[86:87], v[64:65]
  v_pk_add_f32 v[86:87], v[86:87], v[66:67]
  v_pk_add_f32 v[86:87], v[86:87], v[68:69]
  v_pk_add_f32 v[86:87], v[86:87], v[70:71]
  v_add_f32 v86, v86, v87
  v_mov_b32 v87, v86
  s_nop 1
  v_permlane32_swap_b32 v86, v87
  v_add_f32 v86, v86, v87
  v_mov_b32 v87, v86
  s_nop 1
  v_permlane16_swap_b32 v86, v87
  v_add_f32 v86, v86, v87
  v_mul_f32 v87, s26, v86
  v_mul_f32 v86, s26, v86
  v_pk_fma_f32 v[48:49], v[48:49], s[28:29], v[86:87]
  v_pk_fma_f32 v[50:51], v[50:51], s[28:29], v[86:87]
  v_pk_fma_f32 v[52:53], v[52:53], s[28:29], v[86:87]
  v_pk_fma_f32 v[54:55], v[54:55], s[28:29], v[86:87]
  v_pk_fma_f32 v[56:57], v[56:57], s[28:29], v[86:87]
  v_pk_fma_f32 v[58:59], v[58:59], s[28:29], v[86:87]
  v_pk_fma_f32 v[60:61], v[60:61], s[28:29], v[86:87]
  v_pk_fma_f32 v[62:63], v[62:63], s[28:29], v[86:87]
  v_pk_fma_f32 v[64:65], v[64:65], s[28:29], v[86:87]
  v_pk_fma_f32 v[66:67], v[66:67], s[28:29], v[86:87]
  v_pk_fma_f32 v[68:69], v[68:69], s[28:29], v[86:87]
  v_pk_fma_f32 v[70:71], v[70:71], s[28:29], v[86:87]
  v_cvt_pk_bf16_f32 v48, v48, v49
  v_cvt_pk_bf16_f32 v49, v50, v51
  v_cvt_pk_bf16_f32 v50, v52, v53
  v_cvt_pk_bf16_f32 v51, v54, v55
  v_cvt_pk_bf16_f32 v56, v56, v57
  ds_write_b128 v89, v[48:51] offset:1024
  v_cvt_pk_bf16_f32 v57, v58, v59
  v_cvt_pk_bf16_f32 v58, v60, v61
  v_cvt_pk_bf16_f32 v59, v62, v63
  v_cvt_pk_bf16_f32 v64, v64, v65
  ds_write_b128 v89, v[56:59] offset:2048
  v_cvt_pk_bf16_f32 v65, v66, v67
  v_cvt_pk_bf16_f32 v66, v68, v69
  v_cvt_pk_bf16_f32 v67, v70, v71
  ds_write_b128 v89, v[64:67] offset:3072
main_f1:
  s_waitcnt vmcnt(12)

  v_add_u32 v95, 130464, v1
  s_waitcnt lgkmcnt(0)
  s_barrier
  ds_read_b128 v[160:163], v95 offset:0
  ds_read_b128 v[164:167], v95 offset:1024
  ds_read_b128 v[168:171], v95 offset:2048
  ds_read_b128 v[172:175], v95 offset:3072
  s_waitcnt lgkmcnt(0)
  s_barrier

  s_cmp_ge_u32 s18, 6
  s_cbranch_scc1 main_noE1
main_E0:
  s_setprio 2
  ds_read_b128 v[192:195], v1 offset:0
  ds_read_b128 v[196:199], v1 offset:1024
  ds_read_b128 v[200:203], v1 offset:2048
  ds_read_b128 v[204:207], v1 offset:3072
  ds_read_b128 v[208:211], v1 offset:4096
  ds_read_b128 v[212:215], v1 offset:5120
  v_mfma_f32_16x16x32_bf16 v[148:151], v[72:75], v[72:75], 0
  v_mov_b32 v108, 0x3f803f80
  v_mov_b32 v109, 0x3f803f80
  v_mfma_f32_16x16x32_bf16 v[148:151], v[76:79], v[76:79], v[148:151]
  v_mov_b32 v110, 0x3f803f80
  v_mov_b32 v111, 0x3f803f80
  v_mfma_f32_16x16x32_bf16 v[148:151], v[80:83], v[80:83], v[148:151]
  s_nop 0
  v_mfma_f32_16x16x32_bf16 v[152:155], v[108:111], v[72:75], 0
  v_mfma_f32_16x16x32_bf16 v[152:155], v[108:111], v[76:79], v[152:155]
  v_mfma_f32_16x16x32_bf16 v[152:155], v[108:111], v[80:83], v[152:155]
  v_mfma_f32_16x16x32_bf16 v[216:219], v[20:23], v[72:75], 0
  s_waitcnt lgkmcnt(5)
  v_mfma_f32_16x16x32_bf16 v[112:115], v[192:195], v[72:75], 0
  ds_read_b128 v[192:195], v1 offset:6144
  s_waitcnt lgkmcnt(5)
  v_mfma_f32_16x16x32_bf16 v[112:115], v[196:199], v[76:79], v[112:115]
  ds_read_b128 v[196:199], v1 offset:7168
  v_cndmask_b32 v148, v148, v149, s[32:33]
  s_waitcnt lgkmcnt(5)
  v_mfma_f32_16x16x32_bf16 v[112:115], v[200:203], v[80:83], v[112:115]
  ds_read_b128 v[200:203], v1 offset:8192
  v_cndmask_b32 v150, v150, v151, s[32:33]
  s_waitcnt lgkmcnt(5)
  v_mfma_f32_16x16x32_bf16 v[116:119], v[204:207], v[72:75], 0
  ds_read_b128 v[204:207], v1 offset:9216
  v_cndmask_b32 v148, v148, v150, s[34:35]
  s_waitcnt lgkmcnt(5)
  v_mfma_f32_16x16x32_bf16 v[116:119], v[208:211], v[76:79], v[116:119]
  ds_read_b128 v[208:211], v1 offset:10240
  v_mul_f32 v152, v152, v152
  s_waitcnt lgkmcnt(5)
  v_mfma_f32_16x16x32_bf16 v[116:119], v[212:215], v[80:83], v[116:119]
  ds_read_b128 v[212:215], v1 offset:11264
  v_cvt_pk_bf16_f32 v24, v112, v113
  v_mfma_f32_16x16x32_bf16 v[228:231], v[18:21], v[72:75], 0
  v_cvt_pk_bf16_f32 v25, v114, v115
  v_fma_f32 v148, v152, s43, v148
  v_mfma_f32_16x16x32_bf16 v[240:243], v[20:23], v[76:79], 0
  v_max_f32 v148, 0, v148
  v_add_f32 v148, 0x3a7ba882, v148
  v_mfma_f32_16x16x32_bf16 v[252:255], v[18:21], v[76:79], 0
  v_rsq_f32 v184, v148
  s_waitcnt lgkmcnt(5)
  v_mfma_f32_16x16x32_bf16 v[120:123], v[192:195], v[72:75], 0
  ds_read_b128 v[192:195], v1 offset:12288
  v_cvt_pk_bf16_f32 v26, v116, v117
  s_waitcnt lgkmcnt(5)
  v_mfma_f32_16x16x32_bf16 v[120:123], v[196:199], v[76:79], v[120:123]
  ds_read_b128 v[196:199], v1 offset:13312
  v_cvt_pk_bf16_f32 v27, v118, v119
  s_waitcnt lgkmcnt(5)
  v_mfma_f32_16x16x32_bf16 v[120:123], v[200:203], v[80:83], v[120:123]
  ds_read_b128 v[200:203], v1 offset:14336
  s_waitcnt lgkmcnt(5)
  v_mfma_f32_16x16x32_bf16 v[124:127], v[204:207], v[72:75], 0
  ds_read_b128 v[204:207], v1 offset:15360
  s_waitcnt lgkmcnt(5)
  v_mfma_f32_16x16x32_bf16 v[124:127], v[208:211], v[76:79], v[124:127]
  ds_read_b128 v[208:211], v1 offset:16384
  s_waitcnt lgkmcnt(5)
  v_mfma_f32_16x16x32_bf16 v[124:127], v[212:215], v[80:83], v[124:127]
  ds_read_b128 v[212:215], v1 offset:17408
  v_cvt_pk_bf16_f32 v28, v120, v121
  v_mfma_f32_16x16x32_bf16 v[60:63], v[72:75], v[24:27], 0
  v_cvt_pk_bf16_f32 v29, v122, v123
  v_mfma_f32_16x16x32_bf16 v[44:47], v[18:21], v[80:83], 0
  s_nop 2
  v_cvt_pk_bf16_f32 v30, v124, v125
  s_waitcnt lgkmcnt(5)
  v_mfma_f32_16x16x32_bf16 v[128:131], v[192:195], v[72:75], 0
  ds_read_b128 v[192:195], v1 offset:18432
  v_cvt_pk_bf16_f32 v31, v126, v127
  s_waitcnt lgkmcnt(5)
  v_mfma_f32_16x16x32_bf16 v[128:131], v[196:199], v[76:79], v[128:131]
  ds_read_b128 v[196:199], v1 offset:19456
  s_waitcnt lgkmcnt(5)
  v_mfma_f32_16x16x32_bf16 v[128:131], v[200:203], v[80:83], v[128:131]
  ds_read_b128 v[200:203], v1 offset:20480
  s_waitcnt lgkmcnt(5)
  v_mfma_f32_16x16x32_bf16 v[132:135], v[204:207], v[72:75], 0
  ds_read_b128 v[204:207], v1 offset:21504
  s_waitcnt lgkmcnt(5)
  v_mfma_f32_16x16x32_bf16 v[132:135], v[208:211], v[76:79], v[132:135]
  ds_read_b128 v[208:211], v1 offset:22528
  s_waitcnt lgkmcnt(5)
  v_mfma_f32_16x16x32_bf16 v[132:135], v[212:215], v[80:83], v[132:135]
  ds_read_b128 v[212:215], v1 offset:23552
  v_cvt_pk_bf16_f32 v32, v128, v129
  v_mfma_f32_16x16x32_bf16 v[60:63], v[76:79], v[28:31], v[60:63]
  v_cvt_pk_bf16_f32 v33, v130, v131
  s_nop 3
  v_cvt_pk_bf16_f32 v34, v132, v133
  v_cvt_pk_bf16_f32 v35, v134, v135
  s_waitcnt lgkmcnt(5)
  v_mfma_f32_16x16x32_bf16 v[136:139], v[72:75], v[192:195], 0
  ds_read_b128 v[192:195], v1 offset:24576
  v_mfma_f32_16x16x32_bf16 v[60:63], v[80:83], v[32:35], v[60:63]
  s_waitcnt lgkmcnt(5)
  v_mfma_f32_16x16x32_bf16 v[136:139], v[76:79], v[196:199], v[136:139]
  ds_read_b128 v[196:199], v1 offset:25600
  s_waitcnt lgkmcnt(5)
  v_mfma_f32_16x16x32_bf16 v[136:139], v[80:83], v[200:203], v[136:139]
  ds_read_b128 v[200:203], v1 offset:26624
  s_waitcnt lgkmcnt(5)
  v_mfma_f32_16x16x32_bf16 v[140:143], v[72:75], v[204:207], 0
  ds_read_b128 v[204:207], v1 offset:27648
  s_waitcnt lgkmcnt(5)
  v_mfma_f32_16x16x32_bf16 v[140:143], v[76:79], v[208:211], v[140:143]
  ds_read_b128 v[208:211], v1 offset:28672
  v_mul_f32_dpp v60, v184, v60 quad_perm:[0,0,0,0] row_mask:0xf bank_mask:0xf
  s_waitcnt lgkmcnt(5)
  v_mfma_f32_16x16x32_bf16 v[140:143], v[80:83], v[212:215], v[140:143]
  ds_read_b128 v[212:215], v1 offset:29696
  v_mul_f32_dpp v61, v184, v61 quad_perm:[1,1,1,1] row_mask:0xf bank_mask:0xf
  v_mfma_f32_16x16x32_bf16 v[32:35], v[20:23], v[80:83], 0
  v_mul_f32_dpp v62, v184, v62 quad_perm:[2,2,2,2] row_mask:0xf bank_mask:0xf
  v_mul_f32_dpp v63, v184, v63 quad_perm:[3,3,3,3] row_mask:0xf bank_mask:0xf
  v_max3_f32 v185, v60, v61, v62
  v_cvt_pk_bf16_f32 v148, v136, v137
  s_waitcnt lgkmcnt(5)
  v_mfma_f32_16x16x32_bf16 v[144:147], v[72:75], v[192:195], 0
  ds_read_b128 v[192:195], v1 offset:30720
  v_max_f32 v185, v185, v63
  v_cvt_pk_bf16_f32 v149, v138, v139
  v_mul_f32 v185, v185, v184
  v_cvt_pk_bf16_f32 v150, v140, v141
  v_fma_f32 v60, v60, v184, -v185
  s_waitcnt lgkmcnt(5)
  v_mfma_f32_16x16x32_bf16 v[144:147], v[76:79], v[196:199], v[144:147]
  ds_read_b128 v[196:199], v1 offset:31744
  v_fma_f32 v61, v61, v184, -v185
  s_waitcnt lgkmcnt(5)
  v_mfma_f32_16x16x32_bf16 v[144:147], v[80:83], v[200:203], v[144:147]
  ds_read_b128 v[200:203], v1 offset:32768
  v_fma_f32 v62, v62, v184, -v185
  s_waitcnt lgkmcnt(5)
  v_mfma_f32_16x16x32_bf16 v[112:115], v[72:75], v[204:207], 0
  ds_read_b128 v[204:207], v1 offset:33792
  v_fma_f32 v63, v63, v184, -v185
  s_waitcnt lgkmcnt(5)
  v_mfma_f32_16x16x32_bf16 v[112:115], v[76:79], v[208:211], v[112:115]
  ds_read_b128 v[208:211], v1 offset:34816
  v_exp_f32 v60, v60
  s_waitcnt lgkmcnt(5)
  v_mfma_f32_16x16x32_bf16 v[112:115], v[80:83], v[212:215], v[112:115]
  ds_read_b128 v[212:215], v1 offset:35840
  v_exp_f32 v61, v61
  v_exp_f32 v62, v62
  v_exp_f32 v63, v63
  s_waitcnt lgkmcnt(5)
  v_mfma_f32_16x16x32_bf16 v[116:119], v[72:75], v[192:195], 0
  ds_read_b128 v[192:195], v8 offset:0
  v_add_f32 v185, v60, v61
  v_add_f32 v64, v62, v63
  v_mul_f32_dpp v60, v184, v60 quad_perm:[0,0,0,0] row_mask:0xf bank_mask:0xf
  v_add_f32 v185, v185, v64
  v_mul_f32_dpp v61, v184, v61 quad_perm:[1,1,1,1] row_mask:0xf bank_mask:0xf
  s_waitcnt lgkmcnt(5)
  v_mfma_f32_16x16x32_bf16 v[116:119], v[76:79], v[196:199], v[116:119]
  ds_read_b128 v[196:199], v8 offset:1024
  v_rcp_f32 v185, v185
  s_waitcnt lgkmcnt(5)
  v_mfma_f32_16x16x32_bf16 v[116:119], v[80:83], v[200:203], v[116:119]
  ds_read_b128 v[200:203], v8 offset:2048
  v_mul_f32_dpp v62, v184, v62 quad_perm:[2,2,2,2] row_mask:0xf bank_mask:0xf
  s_waitcnt lgkmcnt(5)
  v_mfma_f32_16x16x32_bf16 v[120:123], v[72:75], v[204:207], 0
  ds_read_b128 v[204:207], v8 offset:3072
  v_mul_f32_dpp v63, v184, v63 quad_perm:[3,3,3,3] row_mask:0xf bank_mask:0xf
  s_waitcnt lgkmcnt(5)
  v_mfma_f32_16x16x32_bf16 v[120:123], v[76:79], v[208:211], v[120:123]
  ds_read_b128 v[208:211], v8 offset:4096
  v_mul_f32 v60, v60, v185
  s_waitcnt lgkmcnt(5)
  v_mfma_f32_16x16x32_bf16 v[120:123], v[80:83], v[212:215], v[120:123]
  v_mul_f32 v61, v61, v185
  v_mul_f32 v62, v62, v185
  v_mul_f32 v63, v63, v185
  v_cvt_pk_bf16_f32 v64, v60, v61
  v_cvt_pk_bf16_f32 v65, v62, v63
  v_cndmask_b32 v186, v64, 0, s[54:55]
  v_cndmask_b32 v187, v65, 0, s[54:55]
  v_cvt_pk_bf16_f32 v151, v142, v143
  v_cvt_pk_bf16_f32 v152, v144, v145
  v_mfma_f32_16x16x16_bf16 v[216:219], v[148:149], v[186:187], v[216:219]
  v_cvt_pk_bf16_f32 v153, v146, v147
  v_cvt_pk_bf16_f32 v154, v112, v113
  v_mfma_f32_16x16x16_bf16 v[228:231], v[150:151], v[186:187], v[228:231]
  v_cvt_pk_bf16_f32 v155, v114, v115
  v_cvt_pk_bf16_f32 v156, v116, v117
  v_mfma_f32_16x16x16_bf16 v[240:243], v[152:153], v[186:187], v[240:243]
  v_cvt_pk_bf16_f32 v157, v118, v119
  v_cvt_pk_bf16_f32 v158, v120, v121
  v_mfma_f32_16x16x16_bf16 v[252:255], v[154:155], v[186:187], v[252:255]
  v_cvt_pk_bf16_f32 v159, v122, v123
  v_cvt_pk_bf16_f32 v72, v216, v217
  v_mfma_f32_16x16x16_bf16 v[32:35], v[156:157], v[186:187], v[32:35]
  v_cvt_pk_bf16_f32 v73, v218, v219
  v_cvt_pk_bf16_f32 v74, v228, v229
  v_mfma_f32_16x16x16_bf16 v[44:47], v[158:159], v[186:187], v[44:47]
  v_cvt_pk_bf16_f32 v75, v230, v231
  v_cvt_pk_bf16_f32 v76, v240, v241
  v_cvt_pk_bf16_f32 v77, v242, v243
  v_mfma_f32_16x16x32_bf16 v[212:215], v[72:75], v[72:75], 0
  v_cvt_pk_bf16_f32 v78, v252, v253
  v_cvt_pk_bf16_f32 v79, v254, v255
  v_mfma_f32_16x16x32_bf16 v[216:219], v[108:111], v[72:75], 0
  v_cvt_pk_bf16_f32 v80, v32, v33
  v_cvt_pk_bf16_f32 v81, v34, v35
  v_mfma_f32_16x16x32_bf16 v[212:215], v[76:79], v[76:79], v[212:215]
  v_cvt_pk_bf16_f32 v82, v44, v45
  v_cvt_pk_bf16_f32 v83, v46, v47
  v_mfma_f32_16x16x32_bf16 v[216:219], v[108:111], v[76:79], v[216:219]
  buffer_store_dwordx4 v[72:75], v91, s[88:91], 0 offen offset:384
  v_mfma_f32_16x16x32_bf16 v[212:215], v[80:83], v[80:83], v[212:215]
  v_mfma_f32_16x16x32_bf16 v[216:219], v[108:111], v[80:83], v[216:219]
  buffer_store_dwordx4 v[76:79], v91, s[88:91], 0 offen offset:448
  s_waitcnt lgkmcnt(4)
  v_mfma_f32_16x16x32_bf16 v[112:115], v[192:195], v[72:75], 0
  ds_read_b128 v[192:195], v8 offset:5120
  s_waitcnt lgkmcnt(4)
  v_mfma_f32_16x16x32_bf16 v[112:115], v[196:199], v[76:79], v[112:115]
  ds_read_b128 v[196:199], v8 offset:6144
  buffer_store_dwordx4 v[80:83], v91, s[88:91], 0 offen offset:512
  s_waitcnt lgkmcnt(4)
  v_mfma_f32_16x16x32_bf16 v[112:115], v[200:203], v[80:83], v[112:115]
  ds_read_b128 v[200:203], v8 offset:7168
  v_cndmask_b32 v212, v212, v213, s[32:33]
  s_waitcnt lgkmcnt(4)
  v_mfma_f32_16x16x32_bf16 v[116:119], v[204:207], v[72:75], 0
  ds_read_b128 v[204:207], v8 offset:8192
  v_cndmask_b32 v214, v214, v215, s[32:33]
  s_waitcnt lgkmcnt(4)
  v_mfma_f32_16x16x32_bf16 v[116:119], v[208:211], v[76:79], v[116:119]
  ds_read_b128 v[208:211], v8 offset:9216
  v_cndmask_b32 v212, v212, v214, s[34:35]
  v_mul_f32 v216, v216, v216
  v_cvt_pk_bf16_f32 v24, v112, v113
  v_fma_f32 v212, v216, s43, v212
  v_cvt_pk_bf16_f32 v25, v114, v115
  v_max_f32 v212, 0, v212
  v_add_f32 v212, 0x3a7ba882, v212
  v_rsq_f32 v236, v212
  s_waitcnt lgkmcnt(4)
  v_mfma_f32_16x16x32_bf16 v[116:119], v[192:195], v[80:83], v[116:119]
  ds_read_b128 v[192:195], v8 offset:10240
  s_waitcnt lgkmcnt(4)
  v_mfma_f32_16x16x32_bf16 v[120:123], v[196:199], v[72:75], 0
  ds_read_b128 v[196:199], v8 offset:11264
  s_waitcnt lgkmcnt(4)
  v_mfma_f32_16x16x32_bf16 v[120:123], v[200:203], v[76:79], v[120:123]
  ds_read_b128 v[200:203], v8 offset:12288
  s_waitcnt lgkmcnt(4)
  v_mfma_f32_16x16x32_bf16 v[120:123], v[204:207], v[80:83], v[120:123]
  ds_read_b128 v[204:207], v8 offset:13312
  v_cvt_pk_bf16_f32 v26, v116, v117
  s_waitcnt lgkmcnt(4)
  v_mfma_f32_16x16x32_bf16 v[124:127], v[208:211], v[72:75], 0
  ds_read_b128 v[208:211], v8 offset:14336
  v_cvt_pk_bf16_f32 v27, v118, v119
  buffer_store_dwordx4 v[24:27], v91, s[88:91], 0 offen offset:0
  s_nop 0
  v_cvt_pk_bf16_f32 v28, v120, v121
  v_mfma_f32_16x16x32_bf16 v[184:187], v[72:75], v[24:27], 0
  v_cvt_pk_bf16_f32 v29, v122, v123
  v_mfma_f32_16x16x32_bf16 v[120:123], v[164:167], v[72:75], 0
  v_mfma_f32_16x16x32_bf16 v[120:123], v[168:171], v[76:79], v[120:123]
  s_waitcnt lgkmcnt(4)
  v_mfma_f32_16x16x32_bf16 v[124:127], v[192:195], v[76:79], v[124:127]
  ds_read_b128 v[192:195], v8 offset:15360
  s_waitcnt lgkmcnt(4)
  v_mfma_f32_16x16x32_bf16 v[124:127], v[196:199], v[80:83], v[124:127]
  ds_read_b128 v[196:199], v8 offset:16384
  s_waitcnt lgkmcnt(4)
  v_mfma_f32_16x16x32_bf16 v[128:131], v[200:203], v[72:75], 0
  ds_read_b128 v[200:203], v8 offset:17408
  s_waitcnt lgkmcnt(4)
  v_mfma_f32_16x16x32_bf16 v[128:131], v[204:207], v[76:79], v[128:131]
  ds_read_b128 v[204:207], v94 offset:0
  s_waitcnt lgkmcnt(4)
  v_mfma_f32_16x16x32_bf16 v[128:131], v[208:211], v[80:83], v[128:131]
  ds_read_b128 v[208:211], v94 offset:1024
  v_cvt_pk_bf16_f32 v30, v124, v125
  v_mfma_f32_16x16x32_bf16 v[120:123], v[172:175], v[80:83], v[120:123]
  v_cvt_pk_bf16_f32 v31, v126, v127
  buffer_store_dwordx4 v[28:31], v91, s[88:91], 0 offen offset:64
  s_nop 0
  v_mfma_f32_16x16x32_bf16 v[184:187], v[76:79], v[28:31], v[184:187]
  s_nop 0
  v_cvt_pk_bf16_f32 v32, v128, v129
  v_cvt_pk_bf16_f32 v33, v130, v131
  s_nop 0
  v_cvt_pk_bf16_f32 v158, v120, v121
  s_waitcnt lgkmcnt(4)
  v_mfma_f32_16x16x32_bf16 v[132:135], v[192:195], v[72:75], 0
  ds_read_b128 v[192:195], v94 offset:2048
  v_cvt_pk_bf16_f32 v159, v122, v123
  s_waitcnt lgkmcnt(4)
  v_mfma_f32_16x16x32_bf16 v[132:135], v[196:199], v[76:79], v[132:135]
  ds_read_b128 v[196:199], v94 offset:3072
  s_waitcnt lgkmcnt(4)
  v_mfma_f32_16x16x32_bf16 v[132:135], v[200:203], v[80:83], v[132:135]
  ds_read_b128 v[200:203], v94 offset:4096
  s_waitcnt lgkmcnt(4)
  v_mfma_f32_16x16x32_bf16 v[136:139], v[204:207], v[72:75], 0
  ds_read_b128 v[204:207], v94 offset:5120
  s_waitcnt lgkmcnt(4)
  v_mfma_f32_16x16x32_bf16 v[136:139], v[208:211], v[76:79], v[136:139]
  ds_read_b128 v[208:211], v94 offset:6144
  s_nop 0
  v_cvt_pk_bf16_f32 v34, v132, v133
  v_cvt_pk_bf16_f32 v35, v134, v135
  buffer_store_dwordx4 v[32:35], v91, s[88:91], 0 offen offset:128
  s_nop 0
  v_mfma_f32_16x16x32_bf16 v[184:187], v[80:83], v[32:35], v[184:187]
  s_waitcnt lgkmcnt(4)
  v_mfma_f32_16x16x32_bf16 v[136:139], v[192:195], v[80:83], v[136:139]
  ds_read_b128 v[192:195], v94 offset:7168
  s_waitcnt lgkmcnt(4)
  v_mfma_f32_16x16x32_bf16 v[140:143], v[196:199], v[72:75], 0
  ds_read_b128 v[196:199], v94 offset:8192
  s_waitcnt lgkmcnt(4)
  v_mfma_f32_16x16x32_bf16 v[140:143], v[200:203], v[76:79], v[140:143]
  ds_read_b128 v[200:203], v94 offset:9216
  s_waitcnt lgkmcnt(4)
  v_mfma_f32_16x16x32_bf16 v[140:143], v[204:207], v[80:83], v[140:143]
  ds_read_b128 v[204:207], v94 offset:10240
  v_cndmask_b32 v184, v184, v185, s[32:33]
  s_waitcnt lgkmcnt(4)
  v_mfma_f32_16x16x32_bf16 v[144:147], v[208:211], v[72:75], 0
  ds_read_b128 v[208:211], v94 offset:11264
  v_cndmask_b32 v186, v186, v187, s[32:33]
  v_cvt_pk_bf16_f32 v148, v136, v137
  v_cndmask_b32 v237, v184, v186, s[34:35]
  v_cvt_pk_bf16_f32 v149, v138, v139
  buffer_store_dwordx2 v[236:237], v93, s[88:91], 0 offen offset:960
  v_cvt_pk_bf16_f32 v150, v140, v141
  v_cvt_pk_bf16_f32 v151, v142, v143
  buffer_store_dwordx4 v[148:151], v91, s[88:91], 0 offen offset:192
  s_waitcnt lgkmcnt(4)
  v_mfma_f32_16x16x32_bf16 v[144:147], v[192:195], v[76:79], v[144:147]
  ds_read_b128 v[192:195], v94 offset:12288
  s_waitcnt lgkmcnt(4)
  v_mfma_f32_16x16x32_bf16 v[144:147], v[196:199], v[80:83], v[144:147]
  ds_read_b128 v[196:199], v94 offset:13312
  s_waitcnt lgkmcnt(4)
  v_mfma_f32_16x16x32_bf16 v[112:115], v[200:203], v[72:75], 0
  ds_read_b128 v[200:203], v8 offset:18432
  s_waitcnt lgkmcnt(4)
  v_mfma_f32_16x16x32_bf16 v[112:115], v[204:207], v[76:79], v[112:115]
  ds_read_b128 v[204:207], v8 offset:19456
  s_waitcnt lgkmcnt(4)
  v_mfma_f32_16x16x32_bf16 v[112:115], v[208:211], v[80:83], v[112:115]
  ds_read_b128 v[208:211], v8 offset:20480
  v_cvt_pk_bf16_f32 v152, v144, v145
  v_cvt_pk_bf16_f32 v153, v146, v147
  s_nop 4
  v_cvt_pk_bf16_f32 v154, v112, v113
  v_cvt_pk_bf16_f32 v155, v114, v115
  buffer_store_dwordx4 v[152:155], v91, s[88:91], 0 offen offset:256
  s_waitcnt lgkmcnt(4)
  v_mfma_f32_16x16x32_bf16 v[116:119], v[192:195], v[72:75], 0
  ds_read_b128 v[192:195], v8 offset:21504
  s_waitcnt lgkmcnt(4)
  v_mfma_f32_16x16x32_bf16 v[116:119], v[196:199], v[76:79], v[116:119]
  ds_read_b128 v[196:199], v8 offset:22528
  v_mfma_f32_16x16x32_bf16 v[116:119], v[160:163], v[80:83], v[116:119]
  s_waitcnt lgkmcnt(4)
  v_mfma_f32_16x16x32_bf16 v[124:127], v[200:203], v[72:75], 0
  ds_read_b128 v[200:203], v8 offset:23552
  s_waitcnt lgkmcnt(4)
  v_mfma_f32_16x16x32_bf16 v[124:127], v[204:207], v[76:79], v[124:127]
  ds_read_b128 v[204:207], v8 offset:24576
  s_waitcnt lgkmcnt(4)
  v_mfma_f32_16x16x32_bf16 v[124:127], v[208:211], v[80:83], v[124:127]
  ds_read_b128 v[208:211], v8 offset:25600
  v_cvt_pk_bf16_f32 v156, v116, v117
  v_cvt_pk_bf16_f32 v157, v118, v119
  buffer_store_dwordx4 v[156:159], v91, s[88:91], 0 offen offset:320
  s_nop 3
  v_cvt_pk_bf16_f32 v60, v124, v125
  v_cvt_pk_bf16_f32 v61, v126, v127
  s_waitcnt lgkmcnt(4)
  v_mfma_f32_16x16x32_bf16 v[128:131], v[192:195], v[72:75], 0
  ds_read_b128 v[192:195], v8 offset:26624
  buffer_store_dwordx2 v[60:61], v92, s[88:91], 0 offen offset:768
  s_waitcnt lgkmcnt(4)
  v_mfma_f32_16x16x32_bf16 v[128:131], v[196:199], v[76:79], v[128:131]
  ds_read_b128 v[196:199], v8 offset:27648
  s_waitcnt lgkmcnt(4)
  v_mfma_f32_16x16x32_bf16 v[128:131], v[200:203], v[80:83], v[128:131]
  ds_read_b128 v[200:203], v8 offset:28672
  s_waitcnt lgkmcnt(4)
  v_mfma_f32_16x16x32_bf16 v[132:135], v[204:207], v[72:75], 0
  ds_read_b128 v[204:207], v8 offset:29696
  s_waitcnt lgkmcnt(4)
  v_mfma_f32_16x16x32_bf16 v[132:135], v[208:211], v[76:79], v[132:135]
  ds_read_b128 v[208:211], v8 offset:30720
  s_nop 0
  v_cvt_pk_bf16_f32 v62, v128, v129
  v_cvt_pk_bf16_f32 v63, v130, v131
  buffer_store_dwordx2 v[62:63], v92, s[88:91], 0 offen offset:800
  s_waitcnt lgkmcnt(4)
  v_mfma_f32_16x16x32_bf16 v[132:135], v[192:195], v[80:83], v[132:135]
  ds_read_b128 v[192:195], v8 offset:31744
  s_waitcnt lgkmcnt(4)
  v_mfma_f32_16x16x32_bf16 v[136:139], v[196:199], v[72:75], 0
  ds_read_b128 v[196:199], v8 offset:32768
  s_nop 3
  v_cvt_pk_bf16_f32 v64, v132, v133
  s_waitcnt lgkmcnt(4)
  v_mfma_f32_16x16x32_bf16 v[136:139], v[200:203], v[76:79], v[136:139]
  ds_read_b128 v[200:203], v8 offset:33792
  v_cvt_pk_bf16_f32 v65, v134, v135
  s_waitcnt lgkmcnt(4)
  v_mfma_f32_16x16x32_bf16 v[136:139], v[204:207], v[80:83], v[136:139]
  ds_read_b128 v[204:207], v8 offset:34816
  buffer_store_dwordx2 v[64:65], v92, s[88:91], 0 offen offset:832
  s_waitcnt lgkmcnt(4)
  v_mfma_f32_16x16x32_bf16 v[140:143], v[208:211], v[72:75], 0
  ds_read_b128 v[208:211], v8 offset:35840
  s_nop 2
  v_cvt_pk_bf16_f32 v66, v136, v137
  v_cvt_pk_bf16_f32 v67, v138, v139
  buffer_store_dwordx2 v[66:67], v92, s[88:91], 0 offen offset:864
  s_waitcnt lgkmcnt(4)
  v_mfma_f32_16x16x32_bf16 v[140:143], v[192:195], v[76:79], v[140:143]
  s_waitcnt lgkmcnt(3)
  v_mfma_f32_16x16x32_bf16 v[140:143], v[196:199], v[80:83], v[140:143]
  s_waitcnt lgkmcnt(2)
  v_mfma_f32_16x16x32_bf16 v[144:147], v[200:203], v[72:75], 0
  s_waitcnt lgkmcnt(1)
  v_mfma_f32_16x16x32_bf16 v[144:147], v[204:207], v[76:79], v[144:147]
  s_waitcnt lgkmcnt(0)
  v_mfma_f32_16x16x32_bf16 v[144:147], v[208:211], v[80:83], v[144:147]
  s_nop 1
  v_cvt_pk_bf16_f32 v68, v140, v141
  v_cvt_pk_bf16_f32 v69, v142, v143
  buffer_store_dwordx2 v[68:69], v92, s[88:91], 0 offen offset:896
  s_nop 2
  v_cvt_pk_bf16_f32 v70, v144, v145
  v_cvt_pk_bf16_f32 v71, v146, v147
  buffer_store_dwordx2 v[70:71], v92, s[88:91], 0 offen offset:928
  s_setprio 0
  s_waitcnt vmcnt(16)
  s_branch main_E2
main_noE1:
  s_cmp_eq_u32 s18, 7
  s_cbranch_scc1 main_E1
  s_add_u32 m0, s45, 0
  s_add_u32 s24, s22, 0
  s_mov_b32 exec_hi, 0xffff
  buffer_load_dwordx4 v3, s[4:7], s24 offen nt lds
  s_mov_b32 exec_hi, -1
  s_add_u32 m0, s45, 784
  s_add_u32 s24, s22, 50135232
  s_mov_b32 exec_hi, 0xffff
  buffer_load_dwordx4 v3, s[4:7], s24 offen nt lds
  s_mov_b32 exec_hi, -1
  s_add_u32 m0, s45, 1568
  s_add_u32 s24, s22, 100270464
  s_mov_b32 exec_hi, 0xffff
  buffer_load_dwordx4 v3, s[4:7], s24 offen nt lds
  s_mov_b32 exec_hi, -1
  s_add_u32 m0, s45, 2352
  s_add_u32 s24, s22, 150405696
  s_mov_b32 exec_hi, 0xffff
  buffer_load_dwordx4 v3, s[4:7], s24 offen nt lds
  s_mov_b32 exec_hi, -1
  s_add_u32 m0, s45, 3152
  s_add_u32 s24, s22, 0
  s_mov_b32 exec_hi, 0xffff
  buffer_load_dwordx4 v4, s[4:7], s24 offen nt lds
  s_mov_b32 exec_hi, -1
  s_add_u32 m0, s45, 3936
  s_add_u32 s24, s22, 50135232
  s_mov_b32 exec_hi, 0xffff
  buffer_load_dwordx4 v4, s[4:7], s24 offen nt lds
  s_mov_b32 exec_hi, -1
  s_add_u32 m0, s45, 4720
  s_add_u32 s24, s22, 100270464
  s_mov_b32 exec_hi, 0xffff
  buffer_load_dwordx4 v4, s[4:7], s24 offen nt lds
  s_mov_b32 exec_hi, -1
  s_add_u32 m0, s45, 5504
  s_add_u32 s24, s22, 150405696
  s_mov_b32 exec_hi, 0xffff
  buffer_load_dwordx4 v4, s[4:7], s24 offen nt lds
  s_mov_b32 exec_hi, -1
  s_add_u32 m0, s45, 6304
  s_add_u32 s24, s22, 0
  s_mov_b32 exec_hi, 0xffff
  buffer_load_dwordx4 v5, s[4:7], s24 offen nt lds
  s_mov_b32 exec_hi, -1
  s_add_u32 m0, s45, 7088
  s_add_u32 s24, s22, 50135232
  s_mov_b32 exec_hi, 0xffff
  buffer_load_dwordx4 v5, s[4:7], s24 offen nt lds
  s_mov_b32 exec_hi, -1
  s_add_u32 m0, s45, 7872
  s_add_u32 s24, s22, 100270464
  s_mov_b32 exec_hi, 0xffff
  buffer_load_dwordx4 v5, s[4:7], s24 offen nt lds
  s_mov_b32 exec_hi, -1
  s_add_u32 m0, s45, 8656
  s_add_u32 s24, s22, 150405696
  s_mov_b32 exec_hi, 0xffff
  buffer_load_dwordx4 v5, s[4:7], s24 offen nt lds
  s_mov_b32 exec_hi, -1
main_E1:
  s_waitcnt vmcnt(0)
main_E2:

  ds_read_b128 v[28:31], v1 offset:0
  ds_read_b128 v[32:35], v1 offset:1024
  ds_read_b128 v[40:43], v1 offset:2048
  ds_read_b128 v[44:47], v1 offset:3072
  ds_read_b128 v[52:55], v1 offset:4096
  ds_read_b128 v[56:59], v1 offset:5120

  s_mov_b32 s70, 0
  s_mov_b32 s71, 0
  s_mov_b32 s72, 0
  s_mov_b32 s73, 0
  s_mov_b32 s74, 0
  s_mov_b32 s75, 0
  s_waitcnt lgkmcnt(0)
  s_lshr_b32 s24, s2, 3
  s_and_b32 s24, s24, s17
  s_and_b32 s24, s24, s19
  s_and_b32 s24, s24, 1
  s_cbranch_scc0 main_s1
  s_waitcnt vmcnt(0)
  s_barrier
  s_barrier
  s_branch main_s1
main_loop:
  s_waitcnt vmcnt(12) lgkmcnt(0)
  s_mov_b32 m0, s52
  s_nop 0
  buffer_load_dwordx4 v1, s[88:91], s46 offen sc1 lds
main_s1:
  ds_read_b128 v[72:75], v6 offset:0
  ds_read_b128 v[76:79], v6 offset:64
  ds_read_b128 v[80:83], v6 offset:128
  ds_read_b128 v[84:87], v6 offset:3152
  ds_read_b128 v[88:91], v6 offset:3216
  ds_read_b128 v[92:95], v6 offset:3280
  ds_read_b128 v[96:99], v6 offset:6304
  ds_read_b128 v[100:103], v6 offset:6368
  ds_read_b128 v[104:107], v6 offset:6432
  ds_read_b128 v[192:195], v1 offset:6144
  ds_read_b128 v[196:199], v1 offset:7168
  ds_read_b128 v[200:203], v1 offset:8192
  ds_read_b128 v[204:207], v1 offset:9216
  ds_read_b128 v[208:211], v1 offset:10240
  ds_read_b128 v[212:215], v1 offset:11264
  v_mov_b32 v108, 0x3f803f80
  v_mov_b32 v109, 0x3f803f80
  v_mov_b32 v110, 0x3f803f80
  v_mov_b32 v111, 0x3f803f80
  s_mov_b64 vcc, s[56:57]
  s_waitcnt lgkmcnt(14)
  v_mfma_f32_16x16x32_bf16 v[148:151], v[72:75], v[72:75], 0
  v_mfma_f32_16x16x32_bf16 v[152:155], v[108:111], v[72:75], 0
  s_waitcnt lgkmcnt(13)
  v_mfma_f32_16x16x32_bf16 v[148:151], v[76:79], v[76:79], v[148:151]
  v_mfma_f32_16x16x32_bf16 v[152:155], v[108:111], v[76:79], v[152:155]
  s_waitcnt lgkmcnt(12)
  v_mfma_f32_16x16x32_bf16 v[148:151], v[80:83], v[80:83], v[148:151]
  v_mfma_f32_16x16x32_bf16 v[152:155], v[108:111], v[80:83], v[152:155]
  s_waitcnt lgkmcnt(11)
  v_mfma_f32_16x16x32_bf16 v[156:159], v[84:87], v[84:87], 0
  v_mfma_f32_16x16x32_bf16 v[160:163], v[108:111], v[84:87], 0
  s_waitcnt lgkmcnt(10)
  v_mfma_f32_16x16x32_bf16 v[156:159], v[88:91], v[88:91], v[156:159]
  v_mfma_f32_16x16x32_bf16 v[160:163], v[108:111], v[88:91], v[160:163]
  s_waitcnt lgkmcnt(9)
  v_mfma_f32_16x16x32_bf16 v[156:159], v[92:95], v[92:95], v[156:159]
  v_mfma_f32_16x16x32_bf16 v[160:163], v[108:111], v[92:95], v[160:163]
  v_cndmask_b32 v148, v148, v149, s[32:33]
  s_waitcnt lgkmcnt(8)
  v_mfma_f32_16x16x32_bf16 v[164:167], v[96:99], v[96:99], 0
  v_cndmask_b32 v150, v150, v151, s[32:33]
  v_mfma_f32_16x16x32_bf16 v[168:171], v[108:111], v[96:99], 0
  v_cndmask_b32 v148, v148, v150, s[34:35]
  s_waitcnt lgkmcnt(7)
  v_mfma_f32_16x16x32_bf16 v[164:167], v[100:103], v[100:103], v[164:167]
  v_cndmask_b32 v156, v156, v157, s[32:33]
  v_cndmask_b32 v158, v158, v159, s[32:33]
  v_mfma_f32_16x16x32_bf16 v[168:171], v[108:111], v[100:103], v[168:171]
  v_cndmask_b32 v156, v156, v158, s[34:35]
  v_cndmask_b32_dpp v152, v160, v152, vcc row_ror:4 row_mask:0xf bank_mask:0xf
  s_waitcnt lgkmcnt(6)
  v_mfma_f32_16x16x32_bf16 v[164:167], v[104:107], v[104:107], v[164:167]
  v_cndmask_b32_dpp v148, v156, v148, vcc row_ror:4 row_mask:0xf bank_mask:0xf
  s_mov_b64 vcc, s[58:59]
  v_mfma_f32_16x16x32_bf16 v[168:171], v[108:111], v[104:107], v[168:171]
  v_mfma_f32_16x16x32_bf16 v[112:115], v[28:31], v[72:75], 0
  v_mfma_f32_16x16x32_bf16 v[116:119], v[28:31], v[84:87], 0
  v_mfma_f32_16x16x32_bf16 v[120:123], v[28:31], v[96:99], 0
  v_mfma_f32_16x16x32_bf16 v[112:115], v[32:35], v[76:79], v[112:115]
  s_nop 0
  v_cndmask_b32 v164, v164, v165, s[32:33]
  v_mfma_f32_16x16x32_bf16 v[116:119], v[32:35], v[88:91], v[116:119]
  v_cndmask_b32 v166, v166, v167, s[32:33]
  v_cndmask_b32_dpp v152, v168, v152, vcc row_ror:8 row_mask:0xf bank_mask:0xf
  v_mfma_f32_16x16x32_bf16 v[120:123], v[32:35], v[100:103], v[120:123]
  v_cndmask_b32 v164, v164, v166, s[34:35]
  v_mul_f32 v152, v152, v152
  v_mfma_f32_16x16x32_bf16 v[112:115], v[40:43], v[80:83], v[112:115]
  v_cndmask_b32_dpp v148, v164, v148, vcc row_ror:8 row_mask:0xf bank_mask:0xf
  s_mov_b64 vcc, s[56:57]
  v_mfma_f32_16x16x32_bf16 v[116:119], v[40:43], v[92:95], v[116:119]
  v_fma_f32 v148, v152, s43, v148
  v_mfma_f32_16x16x32_bf16 v[120:123], v[40:43], v[104:107], v[120:123]
  v_max_f32 v148, 0, v148
  v_add_f32 v148, 0x3a7ba882, v148
  v_mfma_f32_16x16x32_bf16 v[124:127], v[44:47], v[72:75], 0
  v_cvt_pk_bf16_f32 v24, v112, v113
  v_cvt_pk_bf16_f32 v25, v114, v115
  v_mfma_f32_16x16x32_bf16 v[128:131], v[44:47], v[84:87], 0
  v_cvt_pk_bf16_f32 v36, v116, v117
  v_cvt_pk_bf16_f32 v37, v118, v119
  v_mfma_f32_16x16x32_bf16 v[132:135], v[44:47], v[96:99], 0
  v_cvt_pk_bf16_f32 v48, v120, v121
  v_cvt_pk_bf16_f32 v49, v122, v123
  v_mfma_f32_16x16x32_bf16 v[124:127], v[52:55], v[76:79], v[124:127]
  v_rsq_f32 v184, v148
  v_mfma_f32_16x16x32_bf16 v[128:131], v[52:55], v[88:91], v[128:131]
  v_mfma_f32_16x16x32_bf16 v[132:135], v[52:55], v[100:103], v[132:135]
  v_mfma_f32_16x16x32_bf16 v[124:127], v[56:59], v[80:83], v[124:127]
  v_mfma_f32_16x16x32_bf16 v[128:131], v[56:59], v[92:95], v[128:131]
  v_mfma_f32_16x16x32_bf16 v[132:135], v[56:59], v[104:107], v[132:135]
  v_mfma_f32_16x16x32_bf16 v[216:219], v[20:23], v[72:75], 0
  v_mfma_f32_16x16x32_bf16 v[220:223], v[20:23], v[84:87], 0
  v_mfma_f32_16x16x32_bf16 v[224:227], v[20:23], v[96:99], 0
  s_waitcnt lgkmcnt(5)
  v_mfma_f32_16x16x32_bf16 v[136:139], v[192:195], v[72:75], 0
  s_nop 0
  v_cvt_pk_bf16_f32 v26, v124, v125
  v_mfma_f32_16x16x32_bf16 v[140:143], v[192:195], v[84:87], 0
  v_cvt_pk_bf16_f32 v27, v126, v127
  v_cvt_pk_bf16_f32 v38, v128, v129
  v_mfma_f32_16x16x32_bf16 v[144:147], v[192:195], v[96:99], 0
  ds_read_b128 v[192:195], v1 offset:12288
  v_cvt_pk_bf16_f32 v39, v130, v131
  s_waitcnt lgkmcnt(5)
  v_mfma_f32_16x16x32_bf16 v[136:139], v[196:199], v[76:79], v[136:139]
  v_cvt_pk_bf16_f32 v50, v132, v133
  v_cvt_pk_bf16_f32 v51, v134, v135
  v_mfma_f32_16x16x32_bf16 v[140:143], v[196:199], v[88:91], v[140:143]
  v_mfma_f32_16x16x32_bf16 v[144:147], v[196:199], v[100:103], v[144:147]
  ds_read_b128 v[196:199], v1 offset:13312
  s_waitcnt lgkmcnt(5)
  v_mfma_f32_16x16x32_bf16 v[136:139], v[200:203], v[80:83], v[136:139]
  v_mfma_f32_16x16x32_bf16 v[140:143], v[200:203], v[92:95], v[140:143]
  v_mfma_f32_16x16x32_bf16 v[144:147], v[200:203], v[104:107], v[144:147]
  ds_read_b128 v[200:203], v1 offset:14336
  v_mfma_f32_16x16x32_bf16 v[228:231], v[18:21], v[72:75], 0
  v_mfma_f32_16x16x32_bf16 v[232:235], v[18:21], v[84:87], 0
  v_mfma_f32_16x16x32_bf16 v[236:239], v[18:21], v[96:99], 0
  s_nop 1
  v_cvt_pk_bf16_f32 v28, v136, v137
  s_waitcnt lgkmcnt(5)
  v_mfma_f32_16x16x32_bf16 v[112:115], v[204:207], v[72:75], 0
  v_cvt_pk_bf16_f32 v29, v138, v139
  v_cvt_pk_bf16_f32 v40, v140, v141
  v_mfma_f32_16x16x32_bf16 v[116:119], v[204:207], v[84:87], 0
  v_cvt_pk_bf16_f32 v41, v142, v143
  v_cvt_pk_bf16_f32 v52, v144, v145
  v_mfma_f32_16x16x32_bf16 v[120:123], v[204:207], v[96:99], 0
  ds_read_b128 v[204:207], v1 offset:15360
  v_cvt_pk_bf16_f32 v53, v146, v147
  s_waitcnt lgkmcnt(5)
  v_mfma_f32_16x16x32_bf16 v[112:115], v[208:211], v[76:79], v[112:115]
  v_mfma_f32_16x16x32_bf16 v[116:119], v[208:211], v[88:91], v[116:119]
  v_mfma_f32_16x16x32_bf16 v[120:123], v[208:211], v[100:103], v[120:123]
  ds_read_b128 v[208:211], v1 offset:16384
  s_waitcnt lgkmcnt(5)
  v_mfma_f32_16x16x32_bf16 v[112:115], v[212:215], v[80:83], v[112:115]
  s_setprio 1
  v_mfma_f32_16x16x32_bf16 v[116:119], v[212:215], v[92:95], v[116:119]
  v_mfma_f32_16x16x32_bf16 v[120:123], v[212:215], v[104:107], v[120:123]
  ds_read_b128 v[212:215], v1 offset:17408
  v_mfma_f32_16x16x32_bf16 v[240:243], v[20:23], v[76:79], 0
  v_mfma_f32_16x16x32_bf16 v[244:247], v[20:23], v[88:91], 0
  v_mfma_f32_16x16x32_bf16 v[248:251], v[20:23], v[100:103], 0
  s_nop 0
  v_cvt_pk_bf16_f32 v30, v112, v113
  s_waitcnt lgkmcnt(5)
  v_mfma_f32_16x16x32_bf16 v[124:127], v[192:195], v[72:75], 0
  v_cvt_pk_bf16_f32 v31, v114, v115
  v_cvt_pk_bf16_f32 v42, v116, v117
  v_mfma_f32_16x16x32_bf16 v[128:131], v[192:195], v[84:87], 0
  v_cvt_pk_bf16_f32 v43, v118, v119
  v_cvt_pk_bf16_f32 v54, v120, v121
  v_mfma_f32_16x16x32_bf16 v[132:135], v[192:195], v[96:99], 0
  ds_read_b128 v[192:195], v1 offset:18432
  v_cvt_pk_bf16_f32 v55, v122, v123
  s_waitcnt lgkmcnt(5)
  v_mfma_f32_16x16x32_bf16 v[124:127], v[196:199], v[76:79], v[124:127]
  v_mfma_f32_16x16x32_bf16 v[128:131], v[196:199], v[88:91], v[128:131]
  v_mfma_f32_16x16x32_bf16 v[132:135], v[196:199], v[100:103], v[132:135]
  ds_read_b128 v[196:199], v1 offset:19456
  s_waitcnt lgkmcnt(5)
  v_mfma_f32_16x16x32_bf16 v[124:127], v[200:203], v[80:83], v[124:127]
  v_mfma_f32_16x16x32_bf16 v[128:131], v[200:203], v[92:95], v[128:131]
  v_mfma_f32_16x16x32_bf16 v[132:135], v[200:203], v[104:107], v[132:135]
  ds_read_b128 v[200:203], v1 offset:20480
  s_waitcnt lgkmcnt(5)
  v_mfma_f32_16x16x32_bf16 v[136:139], v[204:207], v[72:75], 0
  v_mfma_f32_16x16x32_bf16 v[140:143], v[204:207], v[84:87], 0
  v_mfma_f32_16x16x32_bf16 v[144:147], v[204:207], v[96:99], 0
  ds_read_b128 v[204:207], v1 offset:21504
  v_cvt_pk_bf16_f32 v32, v124, v125
  s_waitcnt lgkmcnt(5)
  v_mfma_f32_16x16x32_bf16 v[136:139], v[208:211], v[76:79], v[136:139]
  v_cvt_pk_bf16_f32 v33, v126, v127
  v_cvt_pk_bf16_f32 v44, v128, v129
  v_mfma_f32_16x16x32_bf16 v[140:143], v[208:211], v[88:91], v[140:143]
  v_cvt_pk_bf16_f32 v45, v130, v131
  v_cvt_pk_bf16_f32 v56, v132, v133
  v_mfma_f32_16x16x32_bf16 v[144:147], v[208:211], v[100:103], v[144:147]
  ds_read_b128 v[208:211], v1 offset:22528
  v_cvt_pk_bf16_f32 v57, v134, v135
  s_waitcnt lgkmcnt(5)
  v_mfma_f32_16x16x32_bf16 v[136:139], v[212:215], v[80:83], v[136:139]
  v_mfma_f32_16x16x32_bf16 v[140:143], v[212:215], v[92:95], v[140:143]
  v_mfma_f32_16x16x32_bf16 v[144:147], v[212:215], v[104:107], v[144:147]
  ds_read_b128 v[212:215], v1 offset:23552
  v_mfma_f32_16x16x32_bf16 v[60:63], v[72:75], v[24:27], 0
  v_mfma_f32_16x16x32_bf16 v[64:67], v[84:87], v[36:39], 0
  v_mfma_f32_16x16x32_bf16 v[68:71], v[96:99], v[48:51], 0
  s_nop 1
  v_cvt_pk_bf16_f32 v34, v136, v137
  v_mfma_f32_16x16x32_bf16 v[60:63], v[76:79], v[28:31], v[60:63]
  v_cvt_pk_bf16_f32 v35, v138, v139
  v_cvt_pk_bf16_f32 v46, v140, v141
  v_mfma_f32_16x16x32_bf16 v[64:67], v[88:91], v[40:43], v[64:67]
  v_cvt_pk_bf16_f32 v47, v142, v143
  v_cvt_pk_bf16_f32 v58, v144, v145
  v_mfma_f32_16x16x32_bf16 v[68:71], v[100:103], v[52:55], v[68:71]
  v_cvt_pk_bf16_f32 v59, v146, v147
  v_mfma_f32_16x16x32_bf16 v[60:63], v[80:83], v[32:35], v[60:63]
  v_mfma_f32_16x16x32_bf16 v[64:67], v[92:95], v[44:47], v[64:67]
  v_mfma_f32_16x16x32_bf16 v[68:71], v[104:107], v[56:59], v[68:71]
  s_waitcnt lgkmcnt(5)
  v_mfma_f32_16x16x32_bf16 v[112:115], v[72:75], v[192:195], 0
  v_mfma_f32_16x16x32_bf16 v[116:119], v[84:87], v[192:195], 0
  v_mfma_f32_16x16x32_bf16 v[120:123], v[96:99], v[192:195], 0
  ds_read_b128 v[192:195], v1 offset:24576
  s_waitcnt lgkmcnt(5)
  v_mfma_f32_16x16x32_bf16 v[112:115], v[76:79], v[196:199], v[112:115]
  v_cndmask_b32_dpp v60, v64, v60, vcc row_ror:4 row_mask:0xf bank_mask:0xf
  v_mfma_f32_16x16x32_bf16 v[116:119], v[88:91], v[196:199], v[116:119]
  v_cndmask_b32_dpp v61, v65, v61, vcc row_ror:4 row_mask:0xf bank_mask:0xf
  v_cndmask_b32_dpp v62, v66, v62, vcc row_ror:4 row_mask:0xf bank_mask:0xf
  v_mfma_f32_16x16x32_bf16 v[120:123], v[100:103], v[196:199], v[120:123]
  ds_read_b128 v[196:199], v1 offset:25600
  v_cndmask_b32_dpp v63, v67, v63, vcc row_ror:4 row_mask:0xf bank_mask:0xf
  s_waitcnt lgkmcnt(5)
  v_mfma_f32_16x16x32_bf16 v[112:115], v[80:83], v[200:203], v[112:115]
  s_mov_b64 vcc, s[58:59]
  v_cndmask_b32_dpp v60, v68, v60, vcc row_ror:8 row_mask:0xf bank_mask:0xf
  v_mfma_f32_16x16x32_bf16 v[116:119], v[92:95], v[200:203], v[116:119]
  v_cndmask_b32_dpp v61, v69, v61, vcc row_ror:8 row_mask:0xf bank_mask:0xf
  v_cndmask_b32_dpp v62, v70, v62, vcc row_ror:8 row_mask:0xf bank_mask:0xf
  v_mfma_f32_16x16x32_bf16 v[120:123], v[104:107], v[200:203], v[120:123]
  ds_read_b128 v[200:203], v1 offset:26624
  v_cndmask_b32_dpp v63, v71, v63, vcc row_ror:8 row_mask:0xf bank_mask:0xf
  v_mfma_f32_16x16x32_bf16 v[252:255], v[18:21], v[76:79], 0
  v_mul_f32_dpp v60, v184, v60 quad_perm:[0,0,0,0] row_mask:0xf bank_mask:0xf
  v_mul_f32_dpp v61, v184, v61 quad_perm:[1,1,1,1] row_mask:0xf bank_mask:0xf
  v_mfma_f32_16x16x32_bf16 v[24:27], v[18:21], v[88:91], 0
  v_mul_f32_dpp v62, v184, v62 quad_perm:[2,2,2,2] row_mask:0xf bank_mask:0xf
  v_mul_f32_dpp v63, v184, v63 quad_perm:[3,3,3,3] row_mask:0xf bank_mask:0xf
  v_mfma_f32_16x16x32_bf16 v[28:31], v[18:21], v[100:103], 0
  v_max3_f32 v185, v60, v61, v62
  v_mov_b32 v66, 0
  s_waitcnt lgkmcnt(5)
  v_mfma_f32_16x16x32_bf16 v[124:127], v[72:75], v[204:207], 0
  v_max_f32 v185, v185, v63
  s_mov_b64 vcc, s[54:55]
  v_mfma_f32_16x16x32_bf16 v[128:131], v[84:87], v[204:207], 0
  v_mul_f32 v185, v185, v184
  v_cvt_pk_bf16_f32 v148, v112, v113
  v_mfma_f32_16x16x32_bf16 v[132:135], v[96:99], v[204:207], 0
  ds_read_b128 v[204:207], v1 offset:27648
  v_fma_f32 v60, v60, v184, -v185
  s_waitcnt lgkmcnt(5)
  v_mfma_f32_16x16x32_bf16 v[124:127], v[76:79], v[208:211], v[124:127]
  v_fma_f32 v61, v61, v184, -v185
  v_fma_f32 v62, v62, v184, -v185
  v_mfma_f32_16x16x32_bf16 v[128:131], v[88:91], v[208:211], v[128:131]
  v_fma_f32 v63, v63, v184, -v185
  v_exp_f32 v60, v60
  v_mfma_f32_16x16x32_bf16 v[132:135], v[100:103], v[208:211], v[132:135]
  ds_read_b128 v[208:211], v1 offset:28672
  v_exp_f32 v61, v61
  s_waitcnt lgkmcnt(5)
  v_mfma_f32_16x16x32_bf16 v[124:127], v[80:83], v[212:215], v[124:127]
  v_exp_f32 v62, v62
  v_mfma_f32_16x16x32_bf16 v[128:131], v[92:95], v[212:215], v[128:131]
  v_exp_f32 v63, v63
  v_mfma_f32_16x16x32_bf16 v[132:135], v[104:107], v[212:215], v[132:135]
  ds_read_b128 v[212:215], v1 offset:29696
  v_add_f32 v185, v60, v61
  v_mfma_f32_16x16x32_bf16 v[32:35], v[20:23], v[80:83], 0
  v_add_f32 v64, v62, v63
  v_mul_f32_dpp v60, v184, v60 quad_perm:[0,0,0,0] row_mask:0xf bank_mask:0xf
  v_mfma_f32_16x16x32_bf16 v[36:39], v[20:23], v[92:95], 0
  v_add_f32 v185, v185, v64
  v_mul_f32_dpp v61, v184, v61 quad_perm:[1,1,1,1] row_mask:0xf bank_mask:0xf
  v_mfma_f32_16x16x32_bf16 v[40:43], v[20:23], v[104:107], 0
  v_rcp_f32 v185, v185
  s_waitcnt lgkmcnt(5)
  v_mfma_f32_16x16x32_bf16 v[136:139], v[72:75], v[192:195], 0
  v_mul_f32_dpp v62, v184, v62 quad_perm:[2,2,2,2] row_mask:0xf bank_mask:0xf
  v_mul_f32_dpp v63, v184, v63 quad_perm:[3,3,3,3] row_mask:0xf bank_mask:0xf
  v_mfma_f32_16x16x32_bf16 v[140:143], v[84:87], v[192:195], 0
  v_mul_f32 v60, v60, v185
  v_mul_f32 v61, v61, v185
  v_mfma_f32_16x16x32_bf16 v[144:147], v[96:99], v[192:195], 0
  ds_read_b128 v[192:195], v1 offset:30720
  v_mul_f32 v62, v62, v185
  s_waitcnt lgkmcnt(5)
  v_mfma_f32_16x16x32_bf16 v[136:139], v[76:79], v[196:199], v[136:139]
  v_mul_f32 v63, v63, v185
  v_cvt_pk_bf16_f32 v64, v60, v61
  v_mfma_f32_16x16x32_bf16 v[140:143], v[88:91], v[196:199], v[140:143]
  v_cvt_pk_bf16_f32 v65, v62, v63
  v_cndmask_b32 v186, v64, 0, s[54:55]
  v_mfma_f32_16x16x32_bf16 v[144:147], v[100:103], v[196:199], v[144:147]
  ds_read_b128 v[196:199], v1 offset:31744
  v_cndmask_b32 v187, v65, 0, s[54:55]
  s_waitcnt lgkmcnt(5)
  v_mfma_f32_16x16x32_bf16 v[136:139], v[80:83], v[200:203], v[136:139]
  v_cndmask_b32_dpp v188, v64, v66, vcc row_ror:12 row_mask:0xf bank_mask:0xf
  v_cndmask_b32_dpp v189, v65, v66, vcc row_ror:12 row_mask:0xf bank_mask:0xf
  v_mfma_f32_16x16x32_bf16 v[140:143], v[92:95], v[200:203], v[140:143]
  v_cndmask_b32_dpp v190, v64, v66, vcc row_ror:8 row_mask:0xf bank_mask:0xf
  v_cndmask_b32_dpp v191, v65, v66, vcc row_ror:8 row_mask:0xf bank_mask:0xf
  v_mfma_f32_16x16x32_bf16 v[144:147], v[104:107], v[200:203], v[144:147]
  ds_read_b128 v[200:203], v1 offset:32768
  v_cvt_pk_bf16_f32 v149, v114, v115
  v_mfma_f32_16x16x32_bf16 v[44:47], v[18:21], v[80:83], 0
  v_cvt_pk_bf16_f32 v160, v116, v117
  v_cvt_pk_bf16_f32 v161, v118, v119
  v_mfma_f32_16x16x32_bf16 v[48:51], v[18:21], v[92:95], 0
  v_cvt_pk_bf16_f32 v172, v120, v121
  v_cvt_pk_bf16_f32 v173, v122, v123
  v_mfma_f32_16x16x32_bf16 v[52:55], v[18:21], v[104:107], 0
  v_cvt_pk_bf16_f32 v150, v124, v125
  v_cvt_pk_bf16_f32 v151, v126, v127
  s_waitcnt lgkmcnt(5)
  v_mfma_f32_16x16x32_bf16 v[112:115], v[72:75], v[204:207], 0
  v_cvt_pk_bf16_f32 v162, v128, v129
  v_cvt_pk_bf16_f32 v163, v130, v131
  v_mfma_f32_16x16x32_bf16 v[116:119], v[84:87], v[204:207], 0
  v_cvt_pk_bf16_f32 v174, v132, v133
  s_setprio 0
  v_cvt_pk_bf16_f32 v175, v134, v135
  v_mfma_f32_16x16x32_bf16 v[120:123], v[96:99], v[204:207], 0
  ds_read_b128 v[204:207], v1 offset:33792
  v_cvt_pk_bf16_f32 v152, v136, v137
  s_waitcnt lgkmcnt(5)
  v_mfma_f32_16x16x32_bf16 v[112:115], v[76:79], v[208:211], v[112:115]
  v_cvt_pk_bf16_f32 v153, v138, v139
  v_cvt_pk_bf16_f32 v164, v140, v141
  v_mfma_f32_16x16x32_bf16 v[116:119], v[88:91], v[208:211], v[116:119]
  v_cvt_pk_bf16_f32 v165, v142, v143
  v_cvt_pk_bf16_f32 v176, v144, v145
  v_mfma_f32_16x16x32_bf16 v[120:123], v[100:103], v[208:211], v[120:123]
  ds_read_b128 v[208:211], v1 offset:34816
  v_cvt_pk_bf16_f32 v177, v146, v147
  s_waitcnt lgkmcnt(5)
  v_mfma_f32_16x16x32_bf16 v[112:115], v[80:83], v[212:215], v[112:115]
  v_mfma_f32_16x16x32_bf16 v[116:119], v[92:95], v[212:215], v[116:119]
  v_mfma_f32_16x16x32_bf16 v[120:123], v[104:107], v[212:215], v[120:123]
  ds_read_b128 v[212:215], v1 offset:35840
  s_waitcnt lgkmcnt(5)
  v_mfma_f32_16x16x32_bf16 v[124:127], v[72:75], v[192:195], 0
  v_mfma_f32_16x16x32_bf16 v[128:131], v[84:87], v[192:195], 0
  v_mfma_f32_16x16x32_bf16 v[132:135], v[96:99], v[192:195], 0
  ds_read_b128 v[192:195], v8 offset:0
  v_cvt_pk_bf16_f32 v154, v112, v113
  s_waitcnt lgkmcnt(5)
  v_mfma_f32_16x16x32_bf16 v[124:127], v[76:79], v[196:199], v[124:127]
  v_cvt_pk_bf16_f32 v155, v114, v115
  v_cvt_pk_bf16_f32 v166, v116, v117
  v_mfma_f32_16x16x32_bf16 v[128:131], v[88:91], v[196:199], v[128:131]
  v_cvt_pk_bf16_f32 v167, v118, v119
  v_cvt_pk_bf16_f32 v178, v120, v121
  v_mfma_f32_16x16x32_bf16 v[132:135], v[100:103], v[196:199], v[132:135]
  ds_read_b128 v[196:199], v8 offset:1024
  v_cvt_pk_bf16_f32 v179, v122, v123
  s_waitcnt lgkmcnt(5)
  v_mfma_f32_16x16x32_bf16 v[124:127], v[80:83], v[200:203], v[124:127]
  v_mfma_f32_16x16x32_bf16 v[128:131], v[92:95], v[200:203], v[128:131]
  v_mfma_f32_16x16x32_bf16 v[132:135], v[104:107], v[200:203], v[132:135]
  ds_read_b128 v[200:203], v8 offset:2048
  s_waitcnt lgkmcnt(5)
  v_mfma_f32_16x16x32_bf16 v[136:139], v[72:75], v[204:207], 0
  v_mfma_f32_16x16x32_bf16 v[140:143], v[84:87], v[204:207], 0
  v_mfma_f32_16x16x32_bf16 v[144:147], v[96:99], v[204:207], 0
  ds_read_b128 v[204:207], v8 offset:3072
  v_cvt_pk_bf16_f32 v156, v124, v125
  s_waitcnt lgkmcnt(5)
  v_mfma_f32_16x16x32_bf16 v[136:139], v[76:79], v[208:211], v[136:139]
  v_cvt_pk_bf16_f32 v157, v126, v127
  v_cvt_pk_bf16_f32 v168, v128, v129
  v_mfma_f32_16x16x32_bf16 v[140:143], v[88:91], v[208:211], v[140:143]
  v_cvt_pk_bf16_f32 v169, v130, v131
  v_cvt_pk_bf16_f32 v180, v132, v133
  v_mfma_f32_16x16x32_bf16 v[144:147], v[100:103], v[208:211], v[144:147]
  ds_read_b128 v[208:211], v8 offset:4096
  v_cvt_pk_bf16_f32 v181, v134, v135
  s_waitcnt lgkmcnt(5)
  v_mfma_f32_16x16x32_bf16 v[136:139], v[80:83], v[212:215], v[136:139]
  v_mfma_f32_16x16x32_bf16 v[140:143], v[92:95], v[212:215], v[140:143]
  v_mfma_f32_16x16x32_bf16 v[144:147], v[104:107], v[212:215], v[144:147]
  ds_read_b128 v[212:215], v8 offset:5120
  v_mfma_f32_16x16x16_bf16 v[216:219], v[148:149], v[186:187], v[216:219]
  v_mfma_f32_16x16x16_bf16 v[220:223], v[160:161], v[188:189], v[220:223]
  v_mfma_f32_16x16x16_bf16 v[224:227], v[172:173], v[190:191], v[224:227]
  s_nop 1
  v_cvt_pk_bf16_f32 v158, v136, v137
  v_mfma_f32_16x16x16_bf16 v[228:231], v[150:151], v[186:187], v[228:231]
  v_cvt_pk_bf16_f32 v159, v138, v139
  v_cvt_pk_bf16_f32 v170, v140, v141
  v_mfma_f32_16x16x16_bf16 v[232:235], v[162:163], v[188:189], v[232:235]
  v_cvt_pk_bf16_f32 v171, v142, v143
  v_cvt_pk_bf16_f32 v182, v144, v145
  v_mfma_f32_16x16x16_bf16 v[236:239], v[174:175], v[190:191], v[236:239]
  v_cvt_pk_bf16_f32 v183, v146, v147
  v_cvt_pk_bf16_f32 v72, v216, v217
  v_mfma_f32_16x16x16_bf16 v[240:243], v[152:153], v[186:187], v[240:243]
  v_cvt_pk_bf16_f32 v73, v218, v219
  v_cvt_pk_bf16_f32 v84, v220, v221
  v_mfma_f32_16x16x16_bf16 v[244:247], v[164:165], v[188:189], v[244:247]
  v_cvt_pk_bf16_f32 v85, v222, v223
  v_cvt_pk_bf16_f32 v96, v224, v225
  v_mfma_f32_16x16x16_bf16 v[248:251], v[176:177], v[190:191], v[248:251]
  v_cvt_pk_bf16_f32 v97, v226, v227
  v_cvt_pk_bf16_f32 v74, v228, v229
  v_mfma_f32_16x16x16_bf16 v[252:255], v[154:155], v[186:187], v[252:255]
  v_cvt_pk_bf16_f32 v75, v230, v231
  v_cvt_pk_bf16_f32 v86, v232, v233
  v_mfma_f32_16x16x16_bf16 v[24:27], v[166:167], v[188:189], v[24:27]
  ds_write_b128 v6, v[72:75] offset:0
  v_cvt_pk_bf16_f32 v87, v234, v235
  v_mfma_f32_16x16x16_bf16 v[28:31], v[178:179], v[190:191], v[28:31]
  ds_write_b128 v6, v[84:87] offset:3152
  v_cvt_pk_bf16_f32 v98, v236, v237
  v_mfma_f32_16x16x16_bf16 v[32:35], v[156:157], v[186:187], v[32:35]
  v_cvt_pk_bf16_f32 v99, v238, v239
  v_cvt_pk_bf16_f32 v76, v240, v241
  v_mfma_f32_16x16x16_bf16 v[36:39], v[168:169], v[188:189], v[36:39]
  ds_write_b128 v6, v[96:99] offset:6304
  v_cvt_pk_bf16_f32 v77, v242, v243
  v_mfma_f32_16x16x16_bf16 v[40:43], v[180:181], v[190:191], v[40:43]
  v_cvt_pk_bf16_f32 v88, v244, v245
  v_cvt_pk_bf16_f32 v89, v246, v247
  v_mfma_f32_16x16x16_bf16 v[44:47], v[158:159], v[186:187], v[44:47]
  v_cvt_pk_bf16_f32 v100, v248, v249
  v_cvt_pk_bf16_f32 v101, v250, v251
  v_mfma_f32_16x16x16_bf16 v[48:51], v[170:171], v[188:189], v[48:51]
  v_cvt_pk_bf16_f32 v78, v252, v253
  v_cvt_pk_bf16_f32 v79, v254, v255
  v_mfma_f32_16x16x16_bf16 v[52:55], v[182:183], v[190:191], v[52:55]
  ds_write_b128 v6, v[76:79] offset:64
  v_cvt_pk_bf16_f32 v90, v24, v25
  v_cvt_pk_bf16_f32 v91, v26, v27
  v_cvt_pk_bf16_f32 v102, v28, v29
  ds_write_b128 v6, v[88:91] offset:3216
  v_cvt_pk_bf16_f32 v103, v30, v31
  v_cvt_pk_bf16_f32 v80, v32, v33
  ds_write_b128 v6, v[100:103] offset:6368
  v_cvt_pk_bf16_f32 v81, v34, v35
  v_cvt_pk_bf16_f32 v92, v36, v37
  v_cvt_pk_bf16_f32 v93, v38, v39
  v_cvt_pk_bf16_f32 v104, v40, v41
  v_cvt_pk_bf16_f32 v105, v42, v43
  v_cvt_pk_bf16_f32 v82, v44, v45
  v_cvt_pk_bf16_f32 v83, v46, v47
  v_cvt_pk_bf16_f32 v94, v48, v49
  ds_write_b128 v6, v[80:83] offset:128
  v_cvt_pk_bf16_f32 v95, v50, v51
  v_cvt_pk_bf16_f32 v106, v52, v53
  ds_write_b128 v6, v[92:95] offset:3280
  v_cvt_pk_bf16_f32 v107, v54, v55
  ds_write_b128 v6, v[104:107] offset:6432
  s_add_u32 s21, s21, 2
  s_add_u32 s27, s16, s21
  s_mul_hi_u32 s24, s27, s48
  s_mul_i32 s25, s24, 73
  s_sub_u32 s25, s27, s25
  s_mul_i32 s24, s24, 686784
  s_mul_i32 s25, s25, 1344
  s_add_u32 s23, s24, s25
  s_cmp_lt_u32 s21, s17
  s_cselect_b32 s82, s6, 0
  s_lshl_b32 s46, s21, 2
  s_add_u32 s46, s46, s20
  s_lshl_b32 s46, s46, 10
  s_cmp_ge_u32 s21, 4

  s_waitcnt vmcnt(0)
main_b1:
  s_waitcnt lgkmcnt(0)
  s_barrier
  s_cmp_ge_u32 s21, 4
  s_cbranch_scc1 main_s2
  s_lshl_b32 s24, s18, 10
  s_mov_b32 m0, s52
  v_lshrrev_b32 v33, 2, v1
  buffer_load_dwordx4 v1, s[88:91], s24 offen sc1 lds
  v_add_u32 v33, 161664, v33
  v_mov_b32 v31, 0x3f803f80
  ds_write_b32 v33, v31
  s_waitcnt vmcnt(0)
main_s2:
  s_setprio 3
  ds_read_b128 v[24:27], v10 offset:0
  ds_read_b128 v[36:39], v10 offset:12608
  ds_read_b128 v[48:51], v10 offset:25216
  ds_read_b128 v[60:63], v11 offset:0
  ds_read_b128 v[28:31], v10 offset:64
  ds_read_b128 v[40:43], v10 offset:12672
  ds_read_b128 v[52:55], v10 offset:25280
  ds_read_b128 v[64:67], v11 offset:64
  ds_read_b128 v[32:35], v10 offset:128
  ds_read_b128 v[44:47], v10 offset:12736
  ds_read_b128 v[56:59], v10 offset:25344
  ds_read_b128 v[68:71], v11 offset:128
  ds_read_b128 v[240:243], v8 offset:6144
  ds_read_b128 v[244:247], v8 offset:7168
  ds_read_b128 v[248:251], v8 offset:8192
  s_waitcnt lgkmcnt(14)
  ds_read_b128 v[252:255], v8 offset:9216
  s_waitcnt lgkmcnt(14)
  ds_read_b128 v[168:171], v8 offset:10240
  s_waitcnt lgkmcnt(14)
  ds_read_b128 v[172:175], v8 offset:11264
  s_waitcnt lgkmcnt(14)
  ds_read_u16 v182, v16 offset:800
  s_waitcnt lgkmcnt(14)
  ds_read_u16 v190, v16 offset:832
  s_mov_b64 vcc, s[56:57]
  v_mov_b32 v183, 0
  v_mov_b32 v191, 0
  v_mfma_f32_16x16x32_bf16 v[120:123], v[24:27], v[24:27], 0
  v_mfma_f32_16x16x32_bf16 v[84:87], v[60:63], v[24:27], 0
  v_mfma_f32_16x16x32_bf16 v[124:127], v[36:39], v[36:39], 0
  v_mfma_f32_16x16x32_bf16 v[100:103], v[60:63], v[36:39], 0
  v_mfma_f32_16x16x32_bf16 v[128:131], v[48:51], v[48:51], 0
  v_mfma_f32_16x16x32_bf16 v[116:119], v[60:63], v[48:51], 0
  v_mfma_f32_16x16x32_bf16 v[120:123], v[28:31], v[28:31], v[120:123]
  s_waitcnt lgkmcnt(12)
  v_mfma_f32_16x16x32_bf16 v[84:87], v[64:67], v[28:31], v[84:87]
  v_mfma_f32_16x16x32_bf16 v[124:127], v[40:43], v[40:43], v[124:127]
  v_mfma_f32_16x16x32_bf16 v[100:103], v[64:67], v[40:43], v[100:103]
  v_mfma_f32_16x16x32_bf16 v[128:131], v[52:55], v[52:55], v[128:131]
  v_mfma_f32_16x16x32_bf16 v[116:119], v[64:67], v[52:55], v[116:119]
  s_waitcnt lgkmcnt(11)
  v_mfma_f32_16x16x32_bf16 v[120:123], v[32:35], v[32:35], v[120:123]
  s_waitcnt lgkmcnt(8)
  v_mfma_f32_16x16x32_bf16 v[84:87], v[68:71], v[32:35], v[84:87]
  v_mfma_f32_16x16x32_bf16 v[124:127], v[44:47], v[44:47], v[124:127]
  v_mfma_f32_16x16x32_bf16 v[100:103], v[68:71], v[44:47], v[100:103]
  v_mfma_f32_16x16x32_bf16 v[128:131], v[56:59], v[56:59], v[128:131]
  v_mfma_f32_16x16x32_bf16 v[116:119], v[68:71], v[56:59], v[116:119]
  v_mov_b32 v71, s52
  v_mfma_f32_16x16x32_bf16 v[216:219], v[192:195], v[24:27], 0
  v_cndmask_b32 v120, v120, v121, s[32:33]
  v_mfma_f32_16x16x32_bf16 v[220:223], v[192:195], v[36:39], 0
  v_cndmask_b32 v122, v122, v123, s[32:33]
  v_cndmask_b32 v124, v124, v125, s[32:33]
  v_mfma_f32_16x16x32_bf16 v[224:227], v[192:195], v[48:51], 0
  s_nop 0
  ds_read_b32 v119, v71 offset:964
  ds_read_b32 v71, v71 offset:960
  v_mfma_f32_16x16x32_bf16 v[216:219], v[196:199], v[28:31], v[216:219]
  v_cndmask_b32 v120, v120, v122, s[34:35]
  v_cndmask_b32 v126, v126, v127, s[32:33]
  v_mfma_f32_16x16x32_bf16 v[220:223], v[196:199], v[40:43], v[220:223]
  v_cndmask_b32 v124, v124, v126, s[34:35]
  v_cndmask_b32 v128, v128, v129, s[32:33]
  v_mfma_f32_16x16x32_bf16 v[224:227], v[196:199], v[52:55], v[224:227]
  ds_read_u16 v198, v16 offset:864
  v_cndmask_b32 v130, v130, v131, s[32:33]
  v_mfma_f32_16x16x32_bf16 v[216:219], v[200:203], v[32:35], v[216:219]
  v_cndmask_b32 v128, v128, v130, s[34:35]
  v_cndmask_b32_dpp v86, v102, v86, vcc row_ror:4 row_mask:0xf bank_mask:0xf
  v_mfma_f32_16x16x32_bf16 v[220:223], v[200:203], v[44:47], v[220:223]
  v_cndmask_b32_dpp v120, v124, v120, vcc row_ror:4 row_mask:0xf bank_mask:0xf
  s_mov_b64 vcc, s[58:59]
  v_mfma_f32_16x16x32_bf16 v[224:227], v[200:203], v[56:59], v[224:227]
  v_cndmask_b32_dpp v86, v118, v86, vcc row_ror:8 row_mask:0xf bank_mask:0xf
  v_cndmask_b32_dpp v120, v128, v120, vcc row_ror:8 row_mask:0xf bank_mask:0xf
  v_mfma_f32_16x16x32_bf16 v[228:231], v[204:207], v[24:27], 0
  v_mul_f32 v86, v86, v86
  v_cvt_pk_bf16_f32 v132, v216, v217
  v_mfma_f32_16x16x32_bf16 v[232:235], v[204:207], v[36:39], 0
  v_fma_f32 v120, v86, s43, v120
  v_cvt_pk_bf16_f32 v133, v218, v219
  v_mfma_f32_16x16x32_bf16 v[236:239], v[204:207], v[48:51], 0
  ds_read_u16 v206, v16 offset:896
  v_max_f32 v120, 0, v120
  v_mfma_f32_16x16x32_bf16 v[228:231], v[208:211], v[28:31], v[228:231]
  v_add_f32 v120, 0x3a7ba882, v120
  v_cvt_pk_bf16_f32 v144, v220, v221
  v_mfma_f32_16x16x32_bf16 v[232:235], v[208:211], v[40:43], v[232:235]
  v_rsq_f32 v121, v120
  v_mfma_f32_16x16x32_bf16 v[236:239], v[208:211], v[52:55], v[236:239]
  ds_write_b32 v7, v121
  ds_read_b32 v68, v14 offset:1024
  ds_read_b32 v69, v14 offset:1088
  s_waitcnt lgkmcnt(14)
  ds_read_b32 v70, v14 offset:1152
  s_waitcnt lgkmcnt(14)
  ds_read_b128 v[120:123], v12 offset:1024
  s_waitcnt lgkmcnt(14)
  ds_read_b128 v[124:127], v12 offset:1088
  s_waitcnt lgkmcnt(14)
  ds_read_b128 v[128:131], v12 offset:1152
  v_mfma_f32_16x16x32_bf16 v[228:231], v[212:215], v[32:35], v[228:231]
  v_cvt_pk_bf16_f32 v145, v222, v223
  v_cvt_pk_bf16_f32 v156, v224, v225
  v_mfma_f32_16x16x32_bf16 v[232:235], v[212:215], v[44:47], v[232:235]
  v_cvt_pk_bf16_f32 v157, v226, v227
  s_barrier
  s_add_u32 m0, s45, 0
  s_add_u32 s24, s23, 0
  s_mov_b32 exec_hi, 0xffff
  buffer_load_dwordx4 v3, s[80:83], s24 offen nt lds
  s_mov_b32 exec_hi, -1
  v_mfma_f32_16x16x32_bf16 v[236:239], v[212:215], v[56:59], v[236:239]
  s_waitcnt lgkmcnt(14)
  ds_read_u16 v214, v16 offset:928
  v_cvt_pk_bf16_f32 v134, v228, v229
  v_mfma_f32_16x16x32_bf16 v[216:219], v[240:243], v[24:27], 0
  v_cvt_pk_bf16_f32 v135, v230, v231
  v_cvt_pk_bf16_f32 v146, v232, v233
  v_mfma_f32_16x16x32_bf16 v[220:223], v[240:243], v[36:39], 0
  v_cvt_pk_bf16_f32 v147, v234, v235
  s_waitcnt lgkmcnt(10)
  v_fma_f32 v85, v85, v71, v9
  v_mfma_f32_16x16x32_bf16 v[224:227], v[240:243], v[48:51], 0
  ds_read_b128 v[240:243], v8 offset:12288
  v_cvt_pk_bf16_f32 v158, v236, v237
  v_mfma_f32_16x16x32_bf16 v[216:219], v[244:247], v[28:31], v[216:219]
  v_cvt_pk_bf16_f32 v159, v238, v239
  s_waitcnt lgkmcnt(7)
  v_mul_f32_dpp v84, v84, v68 quad_perm:[0,1,2,3] row_mask:1 bank_mask:0xf
  v_mfma_f32_16x16x32_bf16 v[220:223], v[244:247], v[40:43], v[220:223]
  v_mov_b32 v199, 0
  s_waitcnt lgkmcnt(6)
  v_mul_f32_dpp v84, v100, v69 quad_perm:[0,1,2,3] row_mask:2 bank_mask:0xf
  v_mfma_f32_16x16x32_bf16 v[224:227], v[244:247], v[52:55], v[224:227]
  ds_read_b128 v[244:247], v8 offset:13312
  s_waitcnt lgkmcnt(6)
  v_mul_f32_dpp v84, v116, v70 quad_perm:[0,1,2,3] row_mask:4 bank_mask:0xf
  v_mfma_f32_16x16x32_bf16 v[216:219], v[248:251], v[32:35], v[216:219]
  v_fma_f32 v101, v101, v71, v9
  v_mul_f32_dpp v84, v119, v71 quad_perm:[0,1,2,3] row_mask:8 bank_mask:0xf
  v_mfma_f32_16x16x32_bf16 v[220:223], v[248:251], v[44:47], v[220:223]
  v_cndmask_b32 v84, v84, v9, s[36:37]
  v_mov_b32 v207, 0
  v_mfma_f32_16x16x32_bf16 v[224:227], v[248:251], v[56:59], v[224:227]
  s_add_u32 m0, s45, 784
  s_add_u32 s24, s23, 50135232
  s_mov_b32 exec_hi, 0xffff
  buffer_load_dwordx4 v3, s[80:83], s24 offen nt lds
  s_mov_b32 exec_hi, -1
  ds_read_b128 v[248:251], v8 offset:14336
  v_mfma_f32_16x16x32_bf16 v[228:231], v[252:255], v[24:27], 0
  v_cvt_pk_bf16_f32 v136, v216, v217
  v_cvt_pk_bf16_f32 v137, v218, v219
  v_mfma_f32_16x16x32_bf16 v[232:235], v[252:255], v[36:39], 0
  v_cvt_pk_bf16_f32 v148, v220, v221
  v_cvt_pk_bf16_f32 v149, v222, v223
  v_mfma_f32_16x16x32_bf16 v[236:239], v[252:255], v[48:51], 0
  ds_read_b128 v[252:255], v8 offset:15360
  v_cvt_pk_bf16_f32 v160, v224, v225
  v_mfma_f32_16x16x32_bf16 v[228:231], v[168:171], v[28:31], v[228:231]
  v_cvt_pk_bf16_f32 v161, v226, v227
  v_max_f32_dpp v87, v84, v84 row_ror:8 row_mask:0xf bank_mask:0xf
  v_mfma_f32_16x16x32_bf16 v[232:235], v[168:171], v[40:43], v[232:235]
  v_mov_b32 v215, 0
  v_max_f32_dpp v87, v87, v87 row_ror:4 row_mask:0xf bank_mask:0xf
  v_mfma_f32_16x16x32_bf16 v[236:239], v[168:171], v[52:55], v[236:239]
  ds_read_b128 v[168:171], v8 offset:16384
  v_max_f32_dpp v87, v87, v87 row_ror:2 row_mask:0xf bank_mask:0xf
  v_mfma_f32_16x16x32_bf16 v[228:231], v[172:175], v[32:35], v[228:231]
  v_fma_f32 v117, v117, v71, v9
  v_max_f32_dpp v87, v87, v87 row_ror:1 row_mask:0xf bank_mask:0xf
  v_mfma_f32_16x16x32_bf16 v[232:235], v[172:175], v[44:47], v[232:235]
  v_mov_b32 v103, v87
  v_mfma_f32_16x16x32_bf16 v[236:239], v[172:175], v[56:59], v[236:239]
  ds_read_b128 v[172:175], v8 offset:17408
  v_permlane32_swap_b32 v87, v103
  s_add_u32 m0, s45, 1568
  s_add_u32 s24, s23, 100270464
  s_mov_b32 exec_hi, 0xffff
  buffer_load_dwordx4 v3, s[80:83], s24 offen nt lds
  s_mov_b32 exec_hi, -1
  s_waitcnt lgkmcnt(5)
  v_mfma_f32_16x16x32_bf16 v[216:219], v[240:243], v[24:27], 0
  v_max_f32 v87, v87, v103
  v_cvt_pk_bf16_f32 v138, v228, v229
  v_mfma_f32_16x16x32_bf16 v[220:223], v[240:243], v[36:39], 0
  v_mov_b32 v103, v87
  v_cvt_pk_bf16_f32 v139, v230, v231
  v_mfma_f32_16x16x32_bf16 v[224:227], v[240:243], v[48:51], 0
  ds_read_b128 v[240:243], v8 offset:18432
  v_permlane16_swap_b32 v87, v103
  s_waitcnt lgkmcnt(5)
  v_mfma_f32_16x16x32_bf16 v[216:219], v[244:247], v[28:31], v[216:219]
  v_max_f32 v87, v87, v103
  v_cvt_pk_bf16_f32 v150, v232, v233
  v_mfma_f32_16x16x32_bf16 v[220:223], v[244:247], v[40:43], v[220:223]
  v_mul_f32 v87, v87, v71
  v_cvt_pk_bf16_f32 v151, v234, v235
  v_mfma_f32_16x16x32_bf16 v[224:227], v[244:247], v[52:55], v[224:227]
  ds_read_b128 v[244:247], v8 offset:19456
  v_fma_f32 v84, v84, v71, -v87
  s_waitcnt lgkmcnt(5)
  v_mfma_f32_16x16x32_bf16 v[216:219], v[248:251], v[32:35], v[216:219]
  v_exp_f32 v84, v84
  v_mfma_f32_16x16x32_bf16 v[220:223], v[248:251], v[44:47], v[220:223]
  v_cvt_pk_bf16_f32 v162, v236, v237
  v_add_f32_dpp v87, v84, v84 row_ror:8 row_mask:0xf bank_mask:0xf
  v_mfma_f32_16x16x32_bf16 v[224:227], v[248:251], v[56:59], v[224:227]
  ds_read_b128 v[248:251], v8 offset:20480
  v_add_f32_dpp v87, v87, v87 row_ror:4 row_mask:0xf bank_mask:0xf
  s_add_u32 m0, s45, 2352
  s_add_u32 s24, s23, 150405696
  s_mov_b32 exec_hi, 0xffff
  buffer_load_dwordx4 v3, s[80:83], s24 offen nt lds
  s_mov_b32 exec_hi, -1
  s_waitcnt lgkmcnt(5)
  v_mfma_f32_16x16x32_bf16 v[228:231], v[252:255], v[24:27], 0
  v_add_f32_dpp v87, v87, v87 row_ror:2 row_mask:0xf bank_mask:0xf
  v_mul_f32_dpp v84, v84, v68 quad_perm:[0,1,2,3] row_mask:1 bank_mask:0xf
  v_mfma_f32_16x16x32_bf16 v[232:235], v[252:255], v[36:39], 0
  v_add_f32_dpp v87, v87, v87 row_ror:1 row_mask:0xf bank_mask:0xf
  v_mul_f32_dpp v84, v84, v69 quad_perm:[0,1,2,3] row_mask:2 bank_mask:0xf
  s_waitcnt lgkmcnt(4)
  v_mfma_f32_16x16x32_bf16 v[228:231], v[168:171], v[28:31], v[228:231]
  v_mov_b32 v103, v87
  v_mul_f32_dpp v84, v84, v70 quad_perm:[0,1,2,3] row_mask:4 bank_mask:0xf
  v_mfma_f32_16x16x32_bf16 v[232:235], v[168:171], v[40:43], v[232:235]
  v_permlane32_swap_b32 v87, v103
  s_waitcnt lgkmcnt(3)
  v_mfma_f32_16x16x32_bf16 v[228:231], v[172:175], v[32:35], v[228:231]
  v_add_f32 v87, v87, v103
  v_mul_f32_dpp v84, v84, v71 quad_perm:[0,1,2,3] row_mask:8 bank_mask:0xf
  v_mfma_f32_16x16x32_bf16 v[232:235], v[172:175], v[44:47], v[232:235]
  v_mov_b32 v103, v87
  v_cvt_pk_bf16_f32 v163, v238, v239
  v_mfma_f32_16x16x32_bf16 v[236:239], v[252:255], v[48:51], 0
  ds_read_b128 v[252:255], v8 offset:21504
  v_permlane16_swap_b32 v87, v103
  v_mfma_f32_16x16x32_bf16 v[236:239], v[168:171], v[52:55], v[236:239]
  v_add_f32 v87, v87, v103
  v_cvt_pk_bf16_f32 v140, v216, v217
  v_mfma_f32_16x16x32_bf16 v[236:239], v[172:175], v[56:59], v[236:239]
  ds_read_u16 v174, v16 offset:768
  v_rcp_f32 v87, v87
  s_add_u32 m0, s45, 3152
  s_add_u32 s24, s23, 0
  s_mov_b32 exec_hi, 0xffff
  buffer_load_dwordx4 v4, s[80:83], s24 offen nt lds
  s_mov_b32 exec_hi, -1
  v_mfma_f32_16x16x32_bf16 v[72:75], v[24:27], v[132:135], 0
  v_mul_f32 v84, v84, v87
  v_cvt_pk_bf16_f32 v141, v218, v219
  v_mfma_f32_16x16x32_bf16 v[76:79], v[36:39], v[132:135], 0
  v_cvt_pk_bf16_f32 v84, v84, v84
  v_cvt_pk_bf16_f32 v152, v220, v221
  v_mfma_f32_16x16x32_bf16 v[80:83], v[48:51], v[132:135], 0
  ds_write_b16 v17, v84
  ds_read_b128 v[60:63], v12 offset:1280
  ds_read_b128 v[64:67], v12 offset:1344
  v_mfma_f32_16x16x32_bf16 v[72:75], v[28:31], v[136:139], v[72:75]
  v_cvt_pk_bf16_f32 v153, v222, v223
  v_cvt_pk_bf16_f32 v164, v224, v225
  v_mfma_f32_16x16x32_bf16 v[76:79], v[40:43], v[136:139], v[76:79]
  v_cvt_pk_bf16_f32 v165, v226, v227
  v_cvt_pk_bf16_f32 v142, v228, v229
  v_mfma_f32_16x16x32_bf16 v[80:83], v[52:55], v[136:139], v[80:83]
  v_cvt_pk_bf16_f32 v143, v230, v231
  v_cvt_pk_bf16_f32 v154, v232, v233
  v_mfma_f32_16x16x32_bf16 v[88:91], v[24:27], v[144:147], 0
  v_cvt_pk_bf16_f32 v155, v234, v235
  v_cvt_pk_bf16_f32 v166, v236, v237
  v_mfma_f32_16x16x32_bf16 v[72:75], v[32:35], v[140:143], v[72:75]
  v_cvt_pk_bf16_f32 v167, v238, v239
  v_mov_b32 v175, 0
  v_mfma_f32_16x16x32_bf16 v[76:79], v[44:47], v[140:143], v[76:79]
  s_add_u32 m0, s45, 3936
  s_add_u32 s24, s23, 50135232
  s_mov_b32 exec_hi, 0xffff
  buffer_load_dwordx4 v4, s[80:83], s24 offen nt lds
  s_mov_b32 exec_hi, -1
  v_mfma_f32_16x16x32_bf16 v[80:83], v[56:59], v[140:143], v[80:83]
  v_mfma_f32_16x16x32_bf16 v[92:95], v[36:39], v[144:147], 0
  v_mfma_f32_16x16x32_bf16 v[96:99], v[48:51], v[144:147], 0
  s_nop 0
  v_mul_f32 v72, v72, v120
  v_mfma_f32_16x16x32_bf16 v[88:91], v[28:31], v[148:151], v[88:91]
  v_mul_f32 v73, v73, v121
  v_mul_f32 v74, v74, v122
  v_mfma_f32_16x16x32_bf16 v[92:95], v[40:43], v[148:151], v[92:95]
  v_mul_f32 v75, v75, v123
  v_mul_f32 v76, v76, v124
  v_mfma_f32_16x16x32_bf16 v[96:99], v[52:55], v[148:151], v[96:99]
  v_mul_f32 v77, v77, v125
  v_mul_f32 v78, v78, v126
  v_mfma_f32_16x16x32_bf16 v[88:91], v[32:35], v[152:155], v[88:91]
  v_mul_f32 v79, v79, v127
  v_mul_f32 v80, v80, v128
  v_mfma_f32_16x16x32_bf16 v[92:95], v[44:47], v[152:155], v[92:95]
  v_mul_f32 v81, v81, v129
  v_mul_f32 v82, v82, v130
  v_mfma_f32_16x16x32_bf16 v[96:99], v[56:59], v[152:155], v[96:99]
  v_mul_f32 v83, v83, v131
  v_max3_f32 v84, v72, v73, v74
  v_mfma_f32_16x16x32_bf16 v[104:107], v[24:27], v[156:159], 0
  s_add_u32 m0, s45, 4720
  s_add_u32 s24, s23, 100270464
  s_mov_b32 exec_hi, 0xffff
  buffer_load_dwordx4 v4, s[80:83], s24 offen nt lds
  s_mov_b32 exec_hi, -1
  v_max3_f32 v86, v75, v76, v77
  v_mfma_f32_16x16x32_bf16 v[108:111], v[36:39], v[156:159], 0
  v_max3_f32 v84, v84, v78, v79
  v_max3_f32 v86, v86, v80, v81
  v_mfma_f32_16x16x32_bf16 v[112:115], v[48:51], v[156:159], 0
  ds_read_b128 v[156:159], v12 offset:384
  v_max3_f32 v84, v84, v82, v83
  v_mfma_f32_16x16x32_bf16 v[104:107], v[28:31], v[160:163], v[104:107]
  v_max3_f32 v84, v84, v86, v85
  v_mul_f32 v88, v88, v120
  v_mfma_f32_16x16x32_bf16 v[108:111], v[40:43], v[160:163], v[108:111]
  v_mov_b32 v86, v84
  v_mul_f32 v89, v89, v121
  v_mfma_f32_16x16x32_bf16 v[112:115], v[52:55], v[160:163], v[112:115]
  ds_read_b128 v[160:163], v12 offset:448
  v_permlane32_swap_b32 v84, v86
  v_mfma_f32_16x16x32_bf16 v[104:107], v[32:35], v[164:167], v[104:107]
  v_max_f32 v84, v84, v86
  v_mul_f32 v90, v90, v122
  v_mfma_f32_16x16x32_bf16 v[108:111], v[44:47], v[164:167], v[108:111]
  v_mov_b32 v86, v84
  v_mul_f32 v91, v91, v123
  v_mfma_f32_16x16x32_bf16 v[112:115], v[56:59], v[164:167], v[112:115]
  ds_read_b128 v[164:167], v12 offset:512
  v_permlane16_swap_b32 v84, v86
  s_waitcnt lgkmcnt(10)
  v_mfma_f32_16x16x32_bf16 v[216:219], v[24:27], v[240:243], 0
  s_add_u32 m0, s45, 5504
  s_add_u32 s24, s23, 150405696
  s_mov_b32 exec_hi, 0xffff
  buffer_load_dwordx4 v4, s[80:83], s24 offen nt lds
  s_mov_b32 exec_hi, -1
  v_max_f32 v84, v84, v86
  v_mfma_f32_16x16x32_bf16 v[220:223], v[36:39], v[240:243], 0
  v_mul_f32 v84, v84, v68
  v_mul_f32 v92, v92, v124
  v_mfma_f32_16x16x32_bf16 v[224:227], v[48:51], v[240:243], 0
  ds_read_b128 v[240:243], v8 offset:22528
  v_fma_f32 v72, v72, v68, -v84
  s_waitcnt lgkmcnt(10)
  v_mfma_f32_16x16x32_bf16 v[216:219], v[28:31], v[244:247], v[216:219]
  v_fma_f32 v73, v73, v68, -v84
  v_fma_f32 v74, v74, v68, -v84
  v_mfma_f32_16x16x32_bf16 v[220:223], v[40:43], v[244:247], v[220:223]
  v_fma_f32 v75, v75, v68, -v84
  v_fma_f32 v76, v76, v68, -v84
  v_mfma_f32_16x16x32_bf16 v[224:227], v[52:55], v[244:247], v[224:227]
  ds_read_b128 v[244:247], v8 offset:23552
  v_fma_f32 v77, v77, v68, -v84
  s_waitcnt lgkmcnt(10)
  v_mfma_f32_16x16x32_bf16 v[216:219], v[32:35], v[248:251], v[216:219]
  v_fma_f32 v78, v78, v68, -v84
  v_fma_f32 v79, v79, v68, -v84
  v_mfma_f32_16x16x32_bf16 v[220:223], v[44:47], v[248:251], v[220:223]
  v_fma_f32 v80, v80, v68, -v84
  v_fma_f32 v81, v81, v68, -v84
  v_mfma_f32_16x16x32_bf16 v[224:227], v[56:59], v[248:251], v[224:227]
  ds_read_b128 v[248:251], v8 offset:24576
  v_fma_f32 v82, v82, v68, -v84
  s_waitcnt lgkmcnt(10)
  v_mfma_f32_16x16x32_bf16 v[228:231], v[24:27], v[252:255], 0
  v_cvt_pk_bf16_f32 v168, v216, v217
  v_cvt_pk_bf16_f32 v169, v218, v219
  s_add_u32 m0, s45, 6304
  s_add_u32 s24, s23, 0
  s_mov_b32 exec_hi, 0xffff
  buffer_load_dwordx4 v5, s[80:83], s24 offen nt lds
  s_mov_b32 exec_hi, -1
  v_mfma_f32_16x16x32_bf16 v[232:235], v[36:39], v[252:255], 0
  v_cvt_pk_bf16_f32 v170, v220, v221
  v_cvt_pk_bf16_f32 v171, v222, v223
  v_mfma_f32_16x16x32_bf16 v[236:239], v[48:51], v[252:255], 0
  ds_read_b128 v[252:255], v8 offset:25600
  v_cvt_pk_bf16_f32 v172, v224, v225
  s_waitcnt lgkmcnt(3)
  v_mfma_f32_16x16x32_bf16 v[228:231], v[28:31], v[240:243], v[228:231]
  v_cvt_pk_bf16_f32 v173, v226, v227
  v_fma_f32 v83, v83, v68, -v84
  v_mfma_f32_16x16x32_bf16 v[232:235], v[40:43], v[240:243], v[232:235]
  v_fma_f32 v85, v85, v68, -v84
  v_exp_f32 v72, v72
  v_mfma_f32_16x16x32_bf16 v[236:239], v[52:55], v[240:243], v[236:239]
  ds_read_b128 v[240:243], v8 offset:26624
  v_exp_f32 v73, v73
  s_waitcnt lgkmcnt(3)
  v_mfma_f32_16x16x32_bf16 v[228:231], v[32:35], v[244:247], v[228:231]
  v_exp_f32 v74, v74
  v_mfma_f32_16x16x32_bf16 v[232:235], v[44:47], v[244:247], v[232:235]
  v_exp_f32 v75, v75
  v_mfma_f32_16x16x32_bf16 v[236:239], v[56:59], v[244:247], v[236:239]
  ds_read_b128 v[244:247], v8 offset:27648
  v_exp_f32 v76, v76
  s_waitcnt lgkmcnt(3)
  v_mfma_f32_16x16x32_bf16 v[216:219], v[24:27], v[248:251], 0
  s_add_u32 m0, s45, 7088
  s_add_u32 s24, s23, 50135232
  s_mov_b32 exec_hi, 0xffff
  buffer_load_dwordx4 v5, s[80:83], s24 offen nt lds
  s_mov_b32 exec_hi, -1
  v_exp_f32 v77, v77
  v_mfma_f32_16x16x32_bf16 v[220:223], v[36:39], v[248:251], 0
  v_exp_f32 v78, v78
  v_mfma_f32_16x16x32_bf16 v[224:227], v[48:51], v[248:251], 0
  ds_read_b128 v[248:251], v8 offset:28672
  v_exp_f32 v79, v79
  s_waitcnt lgkmcnt(3)
  v_mfma_f32_16x16x32_bf16 v[216:219], v[28:31], v[252:255], v[216:219]
  v_exp_f32 v80, v80
  v_mfma_f32_16x16x32_bf16 v[220:223], v[40:43], v[252:255], v[220:223]
  v_exp_f32 v81, v81
  v_mfma_f32_16x16x32_bf16 v[224:227], v[52:55], v[252:255], v[224:227]
  ds_read_b128 v[252:255], v8 offset:29696
  v_exp_f32 v82, v82
  s_waitcnt lgkmcnt(3)
  v_mfma_f32_16x16x32_bf16 v[216:219], v[32:35], v[240:243], v[216:219]
  v_exp_f32 v83, v83
  v_mfma_f32_16x16x32_bf16 v[220:223], v[44:47], v[240:243], v[220:223]
  v_exp_f32 v85, v85
  v_mfma_f32_16x16x32_bf16 v[224:227], v[56:59], v[240:243], v[224:227]
  ds_read_b128 v[240:243], v8 offset:30720
  v_add_f32 v86, v72, v73
  v_mfma_f32_16x16x32_bf16 v[132:135], v[20:23], v[156:159], 0
  s_add_u32 m0, s45, 7872
  s_add_u32 s24, s23, 100270464
  s_mov_b32 exec_hi, 0xffff
  buffer_load_dwordx4 v5, s[80:83], s24 offen nt lds
  s_mov_b32 exec_hi, -1
  v_add_f32 v87, v74, v75
  v_mfma_f32_16x16x32_bf16 v[136:139], v[18:21], v[156:159], 0
  v_add_f32 v86, v86, v76
  v_add_f32 v87, v87, v77
  v_mfma_f32_16x16x32_bf16 v[140:143], v[20:23], v[160:163], 0
  v_add_f32 v86, v86, v78
  v_add_f32 v87, v87, v79
  v_mfma_f32_16x16x32_bf16 v[144:147], v[18:21], v[160:163], 0
  v_add_f32 v86, v86, v80
  v_add_f32 v87, v87, v81
  v_mfma_f32_16x16x32_bf16 v[148:151], v[20:23], v[164:167], 0
  v_add_f32 v86, v86, v82
  v_add_f32 v87, v87, v83
  v_mfma_f32_16x16x32_bf16 v[152:155], v[18:21], v[164:167], 0
  v_add_f32 v86, v86, v85
  v_mul_f32 v72, v72, v120
  v_mfma_f32_16x16x32_bf16 v[132:135], v[168:171], v[60:63], v[132:135]
  v_add_f32 v86, v86, v87
  v_mul_f32 v73, v73, v121
  v_mfma_f32_16x16x32_bf16 v[132:135], v[172:175], v[64:67], v[132:135]
  v_mov_b32 v87, v86
  v_mul_f32 v74, v74, v122
  v_mfma_f32_16x16x32_bf16 v[156:159], v[20:23], v[24:27], 0
  v_permlane32_swap_b32 v86, v87
  v_mfma_f32_16x16x32_bf16 v[160:163], v[18:21], v[24:27], 0
  v_add_f32 v86, v86, v87
  v_mul_f32 v75, v75, v123
  s_add_u32 m0, s45, 8656
  s_add_u32 s24, s23, 150405696
  s_mov_b32 exec_hi, 0xffff
  buffer_load_dwordx4 v5, s[80:83], s24 offen nt lds
  s_mov_b32 exec_hi, -1
  v_mfma_f32_16x16x32_bf16 v[164:167], v[20:23], v[28:31], 0
  v_mov_b32 v87, v86
  v_mul_f32 v76, v76, v124
  v_mul_f32 v77, v77, v125
  v_permlane16_swap_b32 v86, v87
  v_mul_f32 v78, v78, v126
  v_add_f32 v86, v86, v87
  v_mul_f32 v79, v79, v127
  v_rcp_f32 v86, v86
  v_mul_f32 v80, v80, v128
  v_mul_f32 v81, v81, v129
  v_mul_f32 v82, v82, v130
  v_mul_f32 v83, v83, v131
  v_mul_f32 v85, v85, v71
  v_mul_f32 v72, v72, v86
  v_mul_f32 v73, v73, v86
  v_mul_f32 v74, v74, v86
  v_mul_f32 v75, v75, v86
  v_mul_f32 v76, v76, v86
  v_mul_f32 v77, v77, v86
  v_mul_f32 v78, v78, v86
  v_mul_f32 v79, v79, v86
  v_mul_f32 v80, v80, v86
  v_mul_f32 v81, v81, v86
  v_mul_f32 v82, v82, v86
  v_mul_f32 v83, v83, v86
  v_mul_f32 v85, v85, v86
  v_cvt_pk_bf16_f32 v72, v72, v73
  v_cvt_pk_bf16_f32 v73, v74, v75
  v_cvt_pk_bf16_f32 v74, v76, v77
  v_cvt_pk_bf16_f32 v75, v78, v79
  v_cvt_pk_bf16_f32 v76, v80, v81
  v_cvt_pk_bf16_f32 v77, v82, v83
  v_mfma_f32_16x16x32_bf16 v[80:83], v[18:21], v[28:31], 0
  v_cvt_pk_bf16_f32 v78, v85, 0
  v_mov_b32 v79, 0
  v_mfma_f32_16x16x32_bf16 v[84:87], v[20:23], v[32:35], 0
  v_cvt_pk_bf16_f32 v176, v228, v229
  v_cvt_pk_bf16_f32 v177, v230, v231
  s_waitcnt lgkmcnt(3)
  v_mfma_f32_16x16x32_bf16 v[228:231], v[24:27], v[244:247], 0
  v_cvt_pk_bf16_f32 v178, v232, v233
  v_cvt_pk_bf16_f32 v179, v234, v235
  v_mfma_f32_16x16x32_bf16 v[232:235], v[36:39], v[244:247], 0
  v_cvt_pk_bf16_f32 v180, v236, v237
  v_cvt_pk_bf16_f32 v181, v238, v239
  v_mfma_f32_16x16x32_bf16 v[236:239], v[48:51], v[244:247], 0
  ds_read_b128 v[244:247], v8 offset:31744
  v_cvt_pk_bf16_f32 v184, v216, v217
  s_waitcnt lgkmcnt(3)
  v_mfma_f32_16x16x32_bf16 v[228:231], v[28:31], v[248:251], v[228:231]
  v_cvt_pk_bf16_f32 v185, v218, v219
  v_cvt_pk_bf16_f32 v186, v220, v221
  v_mfma_f32_16x16x32_bf16 v[232:235], v[40:43], v[248:251], v[232:235]
  v_cvt_pk_bf16_f32 v187, v222, v223
  v_cvt_pk_bf16_f32 v188, v224, v225
  v_mfma_f32_16x16x32_bf16 v[236:239], v[52:55], v[248:251], v[236:239]
  ds_read_b128 v[248:251], v8 offset:32768
  v_cvt_pk_bf16_f32 v189, v226, v227
  s_waitcnt lgkmcnt(3)
  v_mfma_f32_16x16x32_bf16 v[228:231], v[32:35], v[252:255], v[228:231]
  v_mul_f32 v93, v93, v125
  v_mul_f32 v94, v94, v126
  v_mfma_f32_16x16x32_bf16 v[232:235], v[44:47], v[252:255], v[232:235]
  v_mul_f32 v95, v95, v127
  v_mul_f32 v96, v96, v128
  v_mfma_f32_16x16x32_bf16 v[236:239], v[56:59], v[252:255], v[236:239]
  ds_read_b128 v[252:255], v8 offset:33792
  v_mul_f32 v97, v97, v129
  s_waitcnt lgkmcnt(3)
  v_mfma_f32_16x16x32_bf16 v[216:219], v[24:27], v[240:243], 0
  v_cvt_pk_bf16_f32 v192, v228, v229
  v_cvt_pk_bf16_f32 v193, v230, v231
  v_mfma_f32_16x16x32_bf16 v[220:223], v[36:39], v[240:243], 0
  v_cvt_pk_bf16_f32 v194, v232, v233
  v_cvt_pk_bf16_f32 v195, v234, v235
  v_mfma_f32_16x16x32_bf16 v[224:227], v[48:51], v[240:243], 0
  ds_read_b128 v[240:243], v8 offset:34816
  v_cvt_pk_bf16_f32 v196, v236, v237
  s_waitcnt lgkmcnt(3)
  v_mfma_f32_16x16x32_bf16 v[216:219], v[28:31], v[244:247], v[216:219]
  v_cvt_pk_bf16_f32 v197, v238, v239
  v_mul_f32 v98, v98, v130
  v_mfma_f32_16x16x32_bf16 v[220:223], v[40:43], v[244:247], v[220:223]
  v_mul_f32 v99, v99, v131
  v_max3_f32 v100, v88, v89, v90
  v_mfma_f32_16x16x32_bf16 v[224:227], v[52:55], v[244:247], v[224:227]
  ds_read_b128 v[244:247], v8 offset:35840
  v_max3_f32 v102, v91, v92, v93
  s_waitcnt lgkmcnt(3)
  v_mfma_f32_16x16x32_bf16 v[216:219], v[32:35], v[248:251], v[216:219]
  v_max3_f32 v100, v100, v94, v95
  v_max3_f32 v102, v102, v96, v97
  v_mfma_f32_16x16x32_bf16 v[220:223], v[44:47], v[248:251], v[220:223]
  v_max3_f32 v100, v100, v98, v99
  v_cvt_pk_bf16_f32 v132, v132, v133
  v_mfma_f32_16x16x32_bf16 v[224:227], v[56:59], v[248:251], v[224:227]
  v_max3_f32 v100, v100, v102, v101
  v_cvt_pk_bf16_f32 v133, v134, v135
  s_waitcnt lgkmcnt(2)
  v_mfma_f32_16x16x32_bf16 v[228:231], v[24:27], v[252:255], 0
  v_mov_b32 v102, v100
  v_cvt_pk_bf16_f32 v200, v216, v217
  v_mfma_f32_16x16x32_bf16 v[232:235], v[36:39], v[252:255], 0
  v_permlane32_swap_b32 v100, v102
  v_mfma_f32_16x16x32_bf16 v[236:239], v[48:51], v[252:255], 0
  v_max_f32 v100, v100, v102
  s_setprio 2
  v_cvt_pk_bf16_f32 v201, v218, v219
  s_waitcnt lgkmcnt(1)
  v_mfma_f32_16x16x32_bf16 v[228:231], v[28:31], v[240:243], v[228:231]
  ds_read_b128 v[28:31], v1 offset:0
  v_mov_b32 v102, v100
  v_mfma_f32_16x16x32_bf16 v[232:235], v[40:43], v[240:243], v[232:235]
  v_cvt_pk_bf16_f32 v202, v220, v221
  v_permlane16_swap_b32 v100, v102
  v_mfma_f32_16x16x32_bf16 v[236:239], v[52:55], v[240:243], v[236:239]
  v_max_f32 v100, v100, v102
  v_cvt_pk_bf16_f32 v203, v222, v223
  s_waitcnt lgkmcnt(1)
  v_mfma_f32_16x16x32_bf16 v[228:231], v[32:35], v[244:247], v[228:231]
  v_mul_f32 v100, v100, v69
  v_cvt_pk_bf16_f32 v204, v224, v225
  v_mfma_f32_16x16x32_bf16 v[232:235], v[44:47], v[244:247], v[232:235]
  v_fma_f32 v88, v88, v69, -v100
  v_fma_f32 v89, v89, v69, -v100
  v_mfma_f32_16x16x32_bf16 v[236:239], v[56:59], v[244:247], v[236:239]
  v_fma_f32 v90, v90, v69, -v100
  v_fma_f32 v91, v91, v69, -v100
  v_mfma_f32_16x16x32_bf16 v[136:139], v[176:179], v[60:63], v[136:139]
  v_fma_f32 v92, v92, v69, -v100
  v_fma_f32 v93, v93, v69, -v100
  v_mfma_f32_16x16x32_bf16 v[140:143], v[184:187], v[60:63], v[140:143]
  v_fma_f32 v94, v94, v69, -v100
  v_fma_f32 v95, v95, v69, -v100
  v_mfma_f32_16x16x32_bf16 v[144:147], v[192:195], v[60:63], v[144:147]
  v_fma_f32 v96, v96, v69, -v100
  v_fma_f32 v97, v97, v69, -v100
  v_mfma_f32_16x16x32_bf16 v[148:151], v[200:203], v[60:63], v[148:151]
  v_fma_f32 v98, v98, v69, -v100
  v_fma_f32 v99, v99, v69, -v100
  v_mfma_f32_16x16x32_bf16 v[136:139], v[180:183], v[64:67], v[136:139]
  v_fma_f32 v101, v101, v69, -v100
  v_exp_f32 v88, v88
  v_mfma_f32_16x16x32_bf16 v[140:143], v[188:191], v[64:67], v[140:143]
  v_exp_f32 v89, v89
  v_mfma_f32_16x16x32_bf16 v[144:147], v[196:199], v[64:67], v[144:147]
  v_exp_f32 v90, v90
  v_mfma_f32_16x16x32_bf16 v[156:159], v[168:171], v[72:75], v[156:159]
  v_exp_f32 v91, v91
  v_mfma_f32_16x16x32_bf16 v[160:163], v[176:179], v[72:75], v[160:163]
  v_exp_f32 v92, v92
  v_mfma_f32_16x16x32_bf16 v[164:167], v[184:187], v[72:75], v[164:167]
  v_exp_f32 v93, v93
  v_mfma_f32_16x16x32_bf16 v[80:83], v[192:195], v[72:75], v[80:83]
  v_exp_f32 v94, v94
  v_mfma_f32_16x16x32_bf16 v[84:87], v[200:203], v[72:75], v[84:87]
  v_exp_f32 v95, v95
  v_mfma_f32_16x16x32_bf16 v[156:159], v[172:175], v[76:79], v[156:159]
  v_exp_f32 v96, v96
  v_mfma_f32_16x16x32_bf16 v[160:163], v[180:183], v[76:79], v[160:163]
  v_exp_f32 v97, v97
  v_mfma_f32_16x16x32_bf16 v[164:167], v[188:191], v[76:79], v[164:167]
  v_exp_f32 v98, v98
  v_mfma_f32_16x16x32_bf16 v[80:83], v[196:199], v[76:79], v[80:83]
  v_exp_f32 v99, v99
  v_mfma_f32_16x16x32_bf16 v[216:219], v[20:23], v[36:39], 0
  v_exp_f32 v101, v101
  v_mfma_f32_16x16x32_bf16 v[220:223], v[18:21], v[36:39], 0
  v_add_f32 v102, v88, v89
  v_add_f32 v103, v90, v91
  v_mfma_f32_16x16x32_bf16 v[240:243], v[20:23], v[48:51], 0
  v_add_f32 v102, v102, v92
  v_add_f32 v103, v103, v93
  v_mfma_f32_16x16x32_bf16 v[244:247], v[18:21], v[48:51], 0
  v_add_f32 v102, v102, v94
  v_add_f32 v103, v103, v95
  v_mfma_f32_16x16x32_bf16 v[248:251], v[20:23], v[52:55], 0
  v_add_f32 v102, v102, v96
  v_add_f32 v103, v103, v97
  v_mfma_f32_16x16x32_bf16 v[252:255], v[18:21], v[52:55], 0
  ds_read_b128 v[52:55], v1 offset:4096
  v_add_f32 v102, v102, v98
  v_add_f32 v103, v103, v99
  v_add_f32 v102, v102, v101
  v_mul_f32 v88, v88, v120
  v_add_f32 v102, v102, v103
  v_mul_f32 v89, v89, v121
  v_mov_b32 v103, v102
  v_mul_f32 v90, v90, v122
  v_mul_f32 v91, v91, v123
  v_permlane32_swap_b32 v102, v103
  v_mul_f32 v92, v92, v124
  v_add_f32 v102, v102, v103
  v_mul_f32 v93, v93, v125
  v_mov_b32 v103, v102
  v_mul_f32 v94, v94, v126
  v_mul_f32 v95, v95, v127
  v_permlane16_swap_b32 v102, v103
  v_mul_f32 v96, v96, v128
  v_add_f32 v102, v102, v103
  v_mul_f32 v97, v97, v129
  v_rcp_f32 v102, v102
  v_mul_f32 v98, v98, v130
  v_mul_f32 v99, v99, v131
  v_mul_f32 v101, v101, v71
  v_mul_f32 v88, v88, v102
  v_mul_f32 v89, v89, v102
  v_mul_f32 v90, v90, v102
  v_mul_f32 v91, v91, v102
  v_mul_f32 v92, v92, v102
  v_mul_f32 v93, v93, v102
  v_mul_f32 v94, v94, v102
  v_mul_f32 v95, v95, v102
  v_mul_f32 v96, v96, v102
  v_mul_f32 v97, v97, v102
  v_mul_f32 v98, v98, v102
  v_mul_f32 v99, v99, v102
  v_mul_f32 v101, v101, v102
  v_cvt_pk_bf16_f32 v88, v88, v89
  v_cvt_pk_bf16_f32 v89, v90, v91
  v_cvt_pk_bf16_f32 v90, v92, v93
  v_cvt_pk_bf16_f32 v91, v94, v95
  v_cvt_pk_bf16_f32 v92, v96, v97
  v_cvt_pk_bf16_f32 v93, v98, v99
  v_mfma_f32_16x16x32_bf16 v[216:219], v[168:171], v[88:91], v[216:219]
  v_cvt_pk_bf16_f32 v94, v101, 0
  v_mov_b32 v95, 0
  v_mfma_f32_16x16x32_bf16 v[220:223], v[176:179], v[88:91], v[220:223]
  v_cvt_pk_bf16_f32 v205, v226, v227
  v_cvt_pk_bf16_f32 v208, v228, v229
  v_mfma_f32_16x16x32_bf16 v[224:227], v[20:23], v[40:43], 0
  v_cvt_pk_bf16_f32 v209, v230, v231
  v_cvt_pk_bf16_f32 v210, v232, v233
  v_mfma_f32_16x16x32_bf16 v[148:151], v[204:207], v[64:67], v[148:151]
  v_cvt_pk_bf16_f32 v211, v234, v235
  v_cvt_pk_bf16_f32 v212, v236, v237
  v_mfma_f32_16x16x32_bf16 v[84:87], v[204:207], v[76:79], v[84:87]
  v_cvt_pk_bf16_f32 v213, v238, v239
  v_cvt_pk_bf16_f32 v134, v136, v137
  v_mfma_f32_16x16x32_bf16 v[152:155], v[208:211], v[60:63], v[152:155]
  v_cvt_pk_bf16_f32 v135, v138, v139
  v_cvt_pk_bf16_f32 v140, v140, v141
  v_mfma_f32_16x16x32_bf16 v[152:155], v[212:215], v[64:67], v[152:155]
  buffer_store_dwordx4 v[132:135], v13, s[8:11], s22 offen offset:0
  v_cvt_pk_bf16_f32 v141, v142, v143
  v_mfma_f32_16x16x32_bf16 v[136:139], v[18:21], v[32:35], 0
  ds_read_b128 v[32:35], v1 offset:1024
  v_cvt_pk_bf16_f32 v142, v144, v145
  v_mfma_f32_16x16x32_bf16 v[136:139], v[208:211], v[72:75], v[136:139]
  v_cvt_pk_bf16_f32 v143, v146, v147
  v_cvt_pk_bf16_f32 v148, v148, v149
  v_mfma_f32_16x16x32_bf16 v[136:139], v[212:215], v[76:79], v[136:139]
  v_cvt_pk_bf16_f32 v149, v150, v151
  v_cvt_pk_bf16_f32 v150, v152, v153
  v_mfma_f32_16x16x32_bf16 v[228:231], v[18:21], v[40:43], 0
  ds_read_b128 v[40:43], v1 offset:2048
  v_cvt_pk_bf16_f32 v151, v154, v155
  v_mfma_f32_16x16x32_bf16 v[232:235], v[20:23], v[44:47], 0
  v_cvt_pk_bf16_f32 v156, v156, v157
  v_cvt_pk_bf16_f32 v157, v158, v159
  v_mfma_f32_16x16x32_bf16 v[236:239], v[18:21], v[44:47], 0
  ds_read_b128 v[44:47], v1 offset:3072
  v_cvt_pk_bf16_f32 v158, v160, v161
  v_mfma_f32_16x16x32_bf16 v[224:227], v[184:187], v[88:91], v[224:227]
  v_cvt_pk_bf16_f32 v159, v162, v163
  v_cvt_pk_bf16_f32 v164, v164, v165
  v_mfma_f32_16x16x32_bf16 v[228:231], v[192:195], v[88:91], v[228:231]
  v_cvt_pk_bf16_f32 v165, v166, v167
  v_cvt_pk_bf16_f32 v166, v80, v81
  v_mfma_f32_16x16x32_bf16 v[232:235], v[200:203], v[88:91], v[232:235]
  v_cvt_pk_bf16_f32 v167, v82, v83
  v_cvt_pk_bf16_f32 v84, v84, v85
  v_mfma_f32_16x16x32_bf16 v[236:239], v[208:211], v[88:91], v[236:239]
  buffer_store_dwordx4 v[140:143], v13, s[8:11], s22 offen offset:64
  v_cvt_pk_bf16_f32 v85, v86, v87
  v_mfma_f32_16x16x32_bf16 v[216:219], v[172:175], v[92:95], v[216:219]
  v_cvt_pk_bf16_f32 v86, v136, v137
  v_cvt_pk_bf16_f32 v87, v138, v139
  v_mfma_f32_16x16x32_bf16 v[220:223], v[180:183], v[92:95], v[220:223]
  v_mul_f32 v104, v104, v120
  v_mul_f32 v105, v105, v121
  v_mfma_f32_16x16x32_bf16 v[224:227], v[188:191], v[92:95], v[224:227]
  v_mul_f32 v106, v106, v122
  v_mul_f32 v107, v107, v123
  v_mfma_f32_16x16x32_bf16 v[228:231], v[196:199], v[92:95], v[228:231]
  v_cvt_pk_bf16_f32 v216, v216, v217
  v_cvt_pk_bf16_f32 v217, v218, v219
  v_mfma_f32_16x16x32_bf16 v[232:235], v[204:207], v[92:95], v[232:235]
  v_cvt_pk_bf16_f32 v218, v220, v221
  v_cvt_pk_bf16_f32 v219, v222, v223
  v_mfma_f32_16x16x32_bf16 v[236:239], v[212:215], v[92:95], v[236:239]
  v_cvt_pk_bf16_f32 v224, v224, v225
  v_cvt_pk_bf16_f32 v225, v226, v227
  v_mfma_f32_16x16x32_bf16 v[96:99], v[20:23], v[56:59], 0
  v_cvt_pk_bf16_f32 v226, v228, v229
  v_cvt_pk_bf16_f32 v227, v230, v231
  v_mfma_f32_16x16x32_bf16 v[100:103], v[18:21], v[56:59], 0
  ds_read_b128 v[56:59], v1 offset:5120
  v_cvt_pk_bf16_f32 v232, v232, v233
  v_cvt_pk_bf16_f32 v233, v234, v235
  v_cvt_pk_bf16_f32 v234, v236, v237
  v_cvt_pk_bf16_f32 v235, v238, v239
  v_mul_f32 v108, v108, v124
  v_mul_f32 v109, v109, v125
  v_mul_f32 v110, v110, v126
  buffer_store_dwordx4 v[148:151], v13, s[8:11], s22 offen offset:128
  v_mul_f32 v111, v111, v127
  v_mul_f32 v112, v112, v128
  v_mul_f32 v113, v113, v129
  v_mul_f32 v114, v114, v130
  v_mul_f32 v115, v115, v131
  v_max3_f32 v116, v104, v105, v106
  v_max3_f32 v118, v107, v108, v109
  v_max3_f32 v116, v116, v110, v111
  v_max3_f32 v118, v118, v112, v113
  v_max3_f32 v116, v116, v114, v115
  v_max3_f32 v116, v116, v118, v117
  v_mov_b32 v118, v116
  s_nop 1
  v_permlane32_swap_b32 v116, v118
  v_max_f32 v116, v116, v118
  v_mov_b32 v118, v116
  s_nop 1
  v_permlane16_swap_b32 v116, v118
  v_max_f32 v116, v116, v118
  v_mul_f32 v116, v116, v70
  v_fma_f32 v104, v104, v70, -v116
  v_fma_f32 v105, v105, v70, -v116
  v_fma_f32 v106, v106, v70, -v116
  v_fma_f32 v107, v107, v70, -v116
  v_fma_f32 v108, v108, v70, -v116
  v_fma_f32 v109, v109, v70, -v116
  v_fma_f32 v110, v110, v70, -v116
  v_fma_f32 v111, v111, v70, -v116
  buffer_store_dwordx4 v[156:159], v15, s[8:11], s22 offen offset:0
  v_fma_f32 v112, v112, v70, -v116
  v_fma_f32 v113, v113, v70, -v116
  v_fma_f32 v114, v114, v70, -v116
  v_fma_f32 v115, v115, v70, -v116
  v_fma_f32 v117, v117, v70, -v116
  v_exp_f32 v104, v104
  v_exp_f32 v105, v105
  v_exp_f32 v106, v106
  v_exp_f32 v107, v107
  v_exp_f32 v108, v108
  v_exp_f32 v109, v109
  v_exp_f32 v110, v110
  v_exp_f32 v111, v111
  v_exp_f32 v112, v112
  v_exp_f32 v113, v113
  v_exp_f32 v114, v114
  v_exp_f32 v115, v115
  v_exp_f32 v117, v117
  v_add_f32 v118, v104, v105
  v_add_f32 v119, v106, v107
  v_add_f32 v118, v118, v108
  v_add_f32 v119, v119, v109
  v_add_f32 v118, v118, v110
  v_add_f32 v119, v119, v111
  v_add_f32 v118, v118, v112
  v_add_f32 v119, v119, v113
  buffer_store_dwordx4 v[164:167], v15, s[8:11], s22 offen offset:64
  v_add_f32 v118, v118, v114
  v_add_f32 v119, v119, v115
  v_add_f32 v118, v118, v117
  v_mul_f32 v104, v104, v120
  v_add_f32 v118, v118, v119
  v_mul_f32 v105, v105, v121
  v_mov_b32 v119, v118
  v_mul_f32 v106, v106, v122
  v_mul_f32 v107, v107, v123
  v_permlane32_swap_b32 v118, v119
  v_mul_f32 v108, v108, v124
  v_add_f32 v118, v118, v119
  v_mul_f32 v109, v109, v125
  v_mov_b32 v119, v118
  v_mul_f32 v110, v110, v126
  v_mul_f32 v111, v111, v127
  v_permlane16_swap_b32 v118, v119
  v_mul_f32 v112, v112, v128
  v_add_f32 v118, v118, v119
  v_mul_f32 v113, v113, v129
  v_rcp_f32 v118, v118
  v_mul_f32 v114, v114, v130
  v_mul_f32 v115, v115, v131
  v_mul_f32 v117, v117, v71
  v_mul_f32 v104, v104, v118
  v_mul_f32 v105, v105, v118
  v_mul_f32 v106, v106, v118
  v_mul_f32 v107, v107, v118
  v_mul_f32 v108, v108, v118
  v_mul_f32 v109, v109, v118
  v_mul_f32 v110, v110, v118
  v_mul_f32 v111, v111, v118
  v_mul_f32 v112, v112, v118
  v_mul_f32 v113, v113, v118
  v_mul_f32 v114, v114, v118
  v_mul_f32 v115, v115, v118
  buffer_store_dwordx4 v[84:87], v15, s[8:11], s22 offen offset:128
  v_mul_f32 v117, v117, v118
  v_cvt_pk_bf16_f32 v104, v104, v105
  v_cvt_pk_bf16_f32 v105, v106, v107
  v_cvt_pk_bf16_f32 v106, v108, v109
  v_cvt_pk_bf16_f32 v107, v110, v111
  v_cvt_pk_bf16_f32 v108, v112, v113
  v_cvt_pk_bf16_f32 v109, v114, v115
  v_mfma_f32_16x16x32_bf16 v[240:243], v[168:171], v[104:107], v[240:243]
  v_cvt_pk_bf16_f32 v110, v117, 0
  v_mov_b32 v111, 0
  v_mfma_f32_16x16x32_bf16 v[244:247], v[176:179], v[104:107], v[244:247]
  v_mfma_f32_16x16x32_bf16 v[248:251], v[184:187], v[104:107], v[248:251]
  v_mfma_f32_16x16x32_bf16 v[252:255], v[192:195], v[104:107], v[252:255]
  v_mfma_f32_16x16x32_bf16 v[96:99], v[200:203], v[104:107], v[96:99]
  v_mfma_f32_16x16x32_bf16 v[100:103], v[208:211], v[104:107], v[100:103]
  v_mfma_f32_16x16x32_bf16 v[240:243], v[172:175], v[108:111], v[240:243]
  v_mfma_f32_16x16x32_bf16 v[244:247], v[180:183], v[108:111], v[244:247]
  buffer_store_dwordx4 v[216:219], v0, s[8:11], s22 offen offset:0
  v_mfma_f32_16x16x32_bf16 v[248:251], v[188:191], v[108:111], v[248:251]
  v_mfma_f32_16x16x32_bf16 v[252:255], v[196:199], v[108:111], v[252:255]
  v_mfma_f32_16x16x32_bf16 v[96:99], v[204:207], v[108:111], v[96:99]
  v_mfma_f32_16x16x32_bf16 v[100:103], v[212:215], v[108:111], v[100:103]
  s_nop 1
  v_cvt_pk_bf16_f32 v240, v240, v241
  v_cvt_pk_bf16_f32 v241, v242, v243
  v_cvt_pk_bf16_f32 v242, v244, v245
  v_cvt_pk_bf16_f32 v243, v246, v247
  v_cvt_pk_bf16_f32 v248, v248, v249
  v_cvt_pk_bf16_f32 v249, v250, v251
  v_cvt_pk_bf16_f32 v250, v252, v253
  v_cvt_pk_bf16_f32 v251, v254, v255
  v_cvt_pk_bf16_f32 v96, v96, v97
  v_cvt_pk_bf16_f32 v97, v98, v99
  v_cvt_pk_bf16_f32 v98, v100, v101
  v_cvt_pk_bf16_f32 v99, v102, v103
  buffer_store_dwordx4 v[224:227], v0, s[8:11], s22 offen offset:64
  buffer_store_dwordx4 v[232:235], v0, s[8:11], s22 offen offset:128
  buffer_store_dwordx4 v[240:243], v2, s[8:11], s22 offen offset:0
  buffer_store_dwordx4 v[248:251], v2, s[8:11], s22 offen offset:64
  buffer_store_dwordx4 v[96:99], v2, s[8:11], s22 offen offset:128
  s_mov_b32 s22, s23
  s_cmp_lt_u32 s21, s17
  s_cbranch_scc1 main_loop
  s_waitcnt vmcnt(12)
main_end:
  s_endpgm
.section .rodata,"a"
.p2align 6
.amdhsa_kernel standalone__video_video_swin__vision_kernel
  .amdhsa_next_free_vgpr 256
  .amdhsa_next_free_sgpr 102
  .amdhsa_accum_offset 256
  .amdhsa_group_segment_fixed_size 0
  .amdhsa_kernarg_size 64
  .amdhsa_user_sgpr_count 2
  .amdhsa_user_sgpr_kernarg_segment_ptr 1
  .amdhsa_system_sgpr_workgroup_id_x 1
.end_amdhsa_kernel
```
